```python
import torch

def _softmax(x, axis=-1):
    return torch.softmax(x, dim=axis)
def _gelu(x):
    return torch.nn.functional.gelu(x, approximate="tanh")
def _silu(x):
    return torch.nn.functional.silu(x)
def _sigmoid(x):
    return torch.sigmoid(x)
def _layernorm(x, axis=-1, eps=1e-5):
    m = x.mean(dim=axis, keepdim=True)
    v = x.var(dim=axis, keepdim=True, unbiased=False)
    return (x - m) / torch.sqrt(v + eps)
def _scatter_add(tgt, idx, src, axis=0):
    return tgt.clone().index_add_(axis, idx, src)
def _segment_sum(src, seg, n):
    out = torch.zeros((n,) + src.shape[1:], dtype=src.dtype)
    return out.index_add_(0, seg, src)
def _pad(x, pw):
    flat = tuple(v for pair in reversed(pw) for v in pair)
    return torch.nn.functional.pad(x, flat)

kernel_name = 'gated_mix__sliding_block_cached__dense_activation_squared_relu__decode'

def setup_inputs():

    _w = (lambda a: (lambda t: t.to(torch.bfloat16) if t.is_floating_point() else t)(torch.as_tensor(a)))
    def _A_setup():
        B, Sq, D = 2, 1, 576
        Hq, Hkv, Sk, Dh = 32, 16, 32768, 128
        assert Hq % Hkv == 0, (Hq, Hkv)
        return {
            "x": _w((lambda *s: torch.randn(*s, dtype=torch.bfloat16) * 0.05)(B, Sq, D)),
            "k_cache": _w((lambda *s: torch.randn(*s, dtype=torch.bfloat16) * 6.4)(B, Hkv, Sk, Dh)),
            "v_cache": _w((lambda *s: torch.randn(*s, dtype=torch.bfloat16) * 0.4)(B, Hkv, Sk, Dh)),
            "wq": _w((lambda *s: torch.randn(*s, dtype=torch.bfloat16) * 6.4)(D, Hq * Dh) * (D ** -0.5)),
            "wo": _w((lambda *s: torch.randn(*s, dtype=torch.bfloat16) * 0.4)(Hq * Dh, D) * ((Hq * Dh) ** -0.5)),
        }
    _A_in = _A_setup()

    def _B_setup():
        B, S, D, F = 2, 1, 576, 4608
        return {
            "x": _w((lambda *s: torch.randn(*s, dtype=torch.bfloat16) * 0.05)(B, S, D)),
            "w1": _w((lambda *s: torch.randn(*s, dtype=torch.bfloat16) * 0.05)(D, F)),
            "b1": _w((lambda *s: torch.randn(*s, dtype=torch.bfloat16) * 0.05)(F)),
            "w2": _w((lambda *s: torch.randn(*s, dtype=torch.bfloat16) * 0.05)(F, D)),
            "b2": _w((lambda *s: torch.randn(*s, dtype=torch.bfloat16) * 0.05)(D)),
        }
    _B_in = _B_setup()

    return {
        "A_x": _A_in["x"],
        "A_k_cache": _A_in["k_cache"],
        "A_v_cache": _A_in["v_cache"],
        "A_wq": _A_in["wq"],
        "A_wo": _A_in["wo"],
        "B_x": _B_in["x"],
        "B_w1": _B_in["w1"],
        "B_b1": _B_in["b1"],
        "B_w2": _B_in["w2"],
        "B_b2": _B_in["b2"],
        "gate_w": _w((lambda *s: torch.randn(*s, dtype=torch.bfloat16) * 0.05)(576) * 16.0),
    }

def reference(A_x, A_k_cache, A_v_cache, A_wq, A_wo, B_x, B_w1, B_b1, B_w2, B_b2, gate_w):
    def _A_ref(x, k_cache, v_cache, wq, wo):
        B, Sq, D = x.shape
        Hq, Dh = 32, 128
        Hkv, Sk = k_cache.shape[1], k_cache.shape[2]
        W = min(4096, max(256, Sk // 4))
        rep = Hq // Hkv
        q = (lambda x, *d: x.permute(*d))((x @ wq).reshape(B, Sq, Hq, Dh), 0, 2, 1, 3)
        k = (lambda x, n, axis: torch.repeat_interleave(x, n, dim=axis))(k_cache[:, :, Sk - W:, :], rep, axis=1)
        v = (lambda x, n, axis: torch.repeat_interleave(x, n, dim=axis))(v_cache[:, :, Sk - W:, :], rep, axis=1)
        scores = torch.einsum("bhqd,bhkd->bhqk", q, k) * (Dh ** -0.5)
        p = _softmax(scores, axis=-1)
        o = torch.einsum("bhqk,bhkd->bhqd", p, v)
        return (lambda x, *d: x.permute(*d))(o, 0, 2, 1, 3).reshape(B, Sq, Hq * Dh) @ wo

    def _B_ref(x, w1, b1, w2, b2):
        h = torch.einsum("bsd,df->bsf", x, w1) + b1
        zero = torch.zeros_like(h)
        r = torch.where(h > zero, h, zero)
        h = r * r
        out = torch.einsum("bsf,fd->bsd", h, w2) + b2
        return out

    x = A_x
    g = _sigmoid((x * gate_w).sum(-1, keepdims=True))
    a = _A_ref(x, A_k_cache, A_v_cache, A_wq, A_wo)
    b = _B_ref(x, B_w1, B_b1, B_w2, B_b2)
    return g * a + (1 - g) * b
```

```asm
; @launch grid=(256,1,1) block=(640,1,1) lds=146432
.amdgcn_target "amdgcn-amd-amdhsa--gfx950"
.text
.globl gated_mix__sliding_block_cached__dense_activation_squared_relu__decode_kernel
.p2align 8
.type gated_mix__sliding_block_cached__dense_activation_squared_relu__decode_kernel,@function
gated_mix__sliding_block_cached__dense_activation_squared_relu__decode_kernel:
    s_cmp_ge_u32 s2, 256
    s_cbranch_scc1 L_end
    s_load_dwordx16 s[16:31], s[0:1], 0
    s_load_dwordx8 s[32:39], s[0:1], 64
    s_load_dwordx4 s[40:43], s[0:1], 96
    v_lshrrev_b32 v1, 6, v0
    v_and_b32 v0, 63, v0
    v_readfirstlane_b32 s3, v1
    s_and_b32 s5, s2, 7
    s_lshr_b32 s6, s2, 3
    s_lshr_b32 s7, s6, 4
    s_lshl_b32 s8, s5, 1
    s_add_u32 s7, s7, s8
    s_getreg_b32 s8, hwreg(HW_REG_XCC_ID, 0, 4)
    s_xor_b32 s5, s5, s8
    s_bfe_u32 s44, s6, 0x10003
    s_and_b32 s45, s6, 7
    s_lshl_b32 s46, s7, 1
    s_add_u32 s46, s46, s44
    v_lshrrev_b32 v2, 4, v0
    v_and_b32 v3, 15, v0
    s_mov_b32 s75, 100000
    v_bfe_u32 v9, v0, 3, 1
    s_cmp_lg_u32 s3, 9
    s_cbranch_scc1 L_nocw2
    s_getpc_b64 s[8:9]
L_pc3:
    s_sub_u32 s8, s8, (L_pc3 - gated_mix__sliding_block_cached__dense_activation_squared_relu__decode_kernel)
    s_subb_u32 s9, s9, 0
    s_lshl_b32 s10, s6, 9
    v_lshl_add_u32 v4, v0, 6, s10
    v_min_u32 v4, (L_end - gated_mix__sliding_block_cached__dense_activation_squared_relu__decode_kernel), v4
    s_mov_b64 exec, 0xff
    global_load_dword v167, v4, s[8:9]
    s_mov_b64 exec, -1
L_nocw2:
    s_cmp_gt_u32 s3, 1
    s_cbranch_scc1 L_bulk
    s_setprio 3
    s_movk_i32 s8, 1152
    v_mul_u32_u24 v4, s8, v9
    v_lshlrev_b32 v5, 4, v3
    s_mov_b32 s50, 2304
    s_mov_b32 s51, 0x20000
    s_mov_b32 s55, 0x20000
    s_cmp_eq_u32 s3, 1
    s_cbranch_scc1 L_s1a
    v_mad_u32_u24 v4, v2, 36, v4
    s_mul_i32 s9, s45, 144
    s_mov_b32 s8, 147456
    v_mad_u32_u24 v5, v2, s8, v5
    s_mul_i32 s10, s45, 589824
    s_lshl_b32 s11, s46, 8
    s_add_u32 s10, s10, s11
    s_mov_b32 s54, 4718592
    s_waitcnt lgkmcnt(0)
    s_mov_b64 s[48:49], s[16:17]
    s_mov_b64 s[52:53], s[22:23]
    s_mov_b64 s[56:57], s[36:37]
    s_movk_i32 s58, 1152
    s_mov_b32 s59, 0x20000
    s_movk_i32 m0, 2048
    v_lshlrev_b32 v6, 4, v0
    buffer_load_dwordx4 v6, s[48:51], 0 offen offset:0 lds
    buffer_load_dwordx4 v6, s[48:51], 0 offen offset:1024 lds
    buffer_load_dwordx4 v6, s[48:51], 0 offen offset:2048 lds
    s_movk_i32 m0, 5120
    s_nop 0
    buffer_load_dwordx4 v6, s[56:59], 0 offen offset:0 lds
    buffer_load_dwordx4 v6, s[56:59], 0 offen offset:1024 lds
    buffer_load_dwordx4 v[40:43], v5, s[52:55], s10 offen nt
    s_add_u32 s10, s10, 8192
    buffer_load_dwordx4 v[44:47], v5, s[52:55], s10 offen nt
    s_add_u32 s10, s10, 8192
    buffer_load_dwordx4 v[48:51], v5, s[52:55], s10 offen nt
    s_add_u32 s10, s10, 8192
    buffer_load_dwordx4 v[52:55], v5, s[52:55], s10 offen nt
    s_add_u32 s10, s10, 8192
    buffer_load_dwordx4 v[56:59], v5, s[52:55], s10 offen nt
    s_add_u32 s10, s10, 8192
    buffer_load_dwordx4 v[60:63], v5, s[52:55], s10 offen nt
    s_add_u32 s10, s10, 8192
    buffer_load_dwordx4 v[64:67], v5, s[52:55], s10 offen nt
    s_add_u32 s10, s10, 8192
    buffer_load_dwordx4 v[68:71], v5, s[52:55], s10 offen nt
    s_add_u32 s10, s10, 8192
    buffer_load_dwordx4 v[72:75], v5, s[52:55], s10 offen nt
    s_add_u32 s10, s10, 8192
    buffer_load_dwordx4 v[76:79], v5, s[52:55], s10 offen nt
    s_add_u32 s10, s10, 8192
    buffer_load_dwordx4 v[80:83], v5, s[52:55], s10 offen nt
    s_add_u32 s10, s10, 8192
    buffer_load_dwordx4 v[84:87], v5, s[52:55], s10 offen nt
    s_add_u32 s10, s10, 8192
    buffer_load_dwordx4 v[88:91], v5, s[52:55], s10 offen nt
    s_add_u32 s10, s10, 8192
    buffer_load_dwordx4 v[92:95], v5, s[52:55], s10 offen nt
    s_add_u32 s10, s10, 8192
    buffer_load_dwordx4 v[96:99], v5, s[52:55], s10 offen nt
    s_add_u32 s10, s10, 8192
    buffer_load_dwordx4 v[100:103], v5, s[52:55], s10 offen nt
    s_add_u32 s10, s10, 8192
    buffer_load_dwordx4 v[104:107], v5, s[52:55], s10 offen nt
    s_add_u32 s10, s10, 8192
    buffer_load_dwordx4 v[108:111], v5, s[52:55], s10 offen nt
    s_add_u32 s10, s10, 8192
    s_mov_b32 s12, s10
    v_mov_b32 v6, 0
    ds_write_b32 v6, v6 offset:1280
    s_branch L_s0b
L_s1a:
    s_and_b32 s8, s45, 3
    s_lshr_b32 s9, s6, 2
    s_and_b32 s9, s9, 3
    s_movk_i32 s10, 72
    v_mad_u32_u24 v4, v2, s10, v4
    s_mul_i32 s10, s8, 288
    s_mov_b32 s11, 331776
    v_mad_u32_u24 v5, v2, s11, v5
    s_mul_i32 s11, s8, 1327104
    s_mul_i32 s12, s7, 576
    s_add_u32 s11, s11, s12
    s_mul_i32 s12, s9, 144
    s_add_u32 s11, s11, s12
    s_mov_b32 s54, 5308416
    s_mov_b32 s14, 0x01ff01ff
    s_mov_b32 s15, 0x01ff01ff
    s_waitcnt lgkmcnt(0)
    s_mov_b64 s[48:49], s[16:17]
    s_mov_b64 s[52:53], s[28:29]
    s_mov_b64 exec, s[14:15]
    buffer_load_dwordx4 v[44:47], v5, s[52:55], s11 offen nt
    s_add_u32 s11, s11, 9216
    buffer_load_dwordx4 v[48:51], v5, s[52:55], s11 offen nt
    s_add_u32 s11, s11, 9216
    buffer_load_dwordx4 v[52:55], v5, s[52:55], s11 offen nt
    s_add_u32 s11, s11, 9216
    buffer_load_dwordx4 v[56:59], v5, s[52:55], s11 offen nt
    s_add_u32 s11, s11, 9216
    buffer_load_dwordx4 v[60:63], v5, s[52:55], s11 offen nt
    s_add_u32 s11, s11, 9216
    buffer_load_dwordx4 v[64:67], v5, s[52:55], s11 offen nt
    s_add_u32 s11, s11, 9216
    buffer_load_dwordx4 v[68:71], v5, s[52:55], s11 offen nt
    s_add_u32 s11, s11, 9216
    buffer_load_dwordx4 v[72:75], v5, s[52:55], s11 offen nt
    s_add_u32 s11, s11, 9216
    buffer_load_dwordx4 v[76:79], v5, s[52:55], s11 offen nt
    s_add_u32 s11, s11, 9216
    buffer_load_dwordx4 v[80:83], v5, s[52:55], s11 offen nt
    s_add_u32 s11, s11, 9216
    buffer_load_dwordx4 v[84:87], v5, s[52:55], s11 offen nt
    s_add_u32 s11, s11, 9216
    buffer_load_dwordx4 v[88:91], v5, s[52:55], s11 offen nt
    s_add_u32 s11, s11, 9216
    buffer_load_dwordx4 v[92:95], v5, s[52:55], s11 offen nt
    s_add_u32 s11, s11, 9216
    buffer_load_dwordx4 v[96:99], v5, s[52:55], s11 offen nt
    s_add_u32 s11, s11, 9216
    buffer_load_dwordx4 v[100:103], v5, s[52:55], s11 offen nt
    s_add_u32 s11, s11, 9216
    buffer_load_dwordx4 v[104:107], v5, s[52:55], s11 offen nt
    s_add_u32 s11, s11, 9216
    buffer_load_dwordx4 v[108:111], v5, s[52:55], s11 offen nt
    s_add_u32 s11, s11, 9216
    buffer_load_dwordx4 v[112:115], v5, s[52:55], s11 offen nt
    s_add_u32 s11, s11, 9216
    buffer_load_dwordx4 v[116:119], v5, s[52:55], s11 offen nt
    s_add_u32 s11, s11, 9216
    buffer_load_dwordx4 v[120:123], v5, s[52:55], s11 offen nt
    s_add_u32 s11, s11, 9216
    buffer_load_dwordx4 v[124:127], v5, s[52:55], s11 offen nt
    s_add_u32 s11, s11, 9216
    buffer_load_dwordx4 v[128:131], v5, s[52:55], s11 offen nt
    s_add_u32 s11, s11, 9216
    buffer_load_dwordx4 v[132:135], v5, s[52:55], s11 offen nt
    s_add_u32 s11, s11, 9216
    buffer_load_dwordx4 v[136:139], v5, s[52:55], s11 offen nt
    s_add_u32 s11, s11, 9216
    s_mov_b64 exec, -1
    s_branch L_s1b
L_bulk:
    s_sub_u32 s4, s3, 2
    s_setprio 1
    s_cmp_lt_u32 s4, 4
    s_cbranch_scc1 L_prio
    s_setprio 2
L_prio:
    s_lshl_b32 s11, s44, 4
    s_add_u32 s11, s11, s7
    s_lshl_b32 s8, s11, 23
    s_lshl_b32 s9, s45, 17
    s_add_u32 s8, s8, s9
    s_add_u32 s8, s8, 0x700000
    s_mul_i32 s11, s2, 0x9e3779b1
    s_bfe_u32 s11, s11, 0x5001b
    s_add_u32 s9, s4, 0
    s_xor_b32 s9, s9, s11
    s_lshl_b32 s64, s9, 12
    s_add_u32 s9, s4, 8
    s_xor_b32 s9, s9, s11
    s_lshl_b32 s65, s9, 12
    s_add_u32 s9, s4, 16
    s_xor_b32 s9, s9, s11
    s_lshl_b32 s66, s9, 12
    s_add_u32 s9, s4, 24
    s_xor_b32 s9, s9, s11
    s_lshl_b32 s67, s9, 12
    v_xor_b32 v4, v3, v2
    v_lshlrev_b32 v4, 4, v4
    v_lshl_add_u32 v4, v2, 8, v4
    v_xor_b32 v5, 64, v4
    v_xor_b32 v6, 0x80, v4
    v_xor_b32 v7, 0xc0, v4
    v_lshlrev_b32 v8, 4, v3
    v_lshl_add_u32 v8, v2, 10, v8
    s_lshl_b32 s10, s4, 14
    s_add_u32 s10, s10, 15360
    s_mov_b32 s50, 0x20000
    s_mov_b32 s51, 0x20000
    s_mov_b32 s54, 0x20000
    s_mov_b32 s55, 0x20000
    s_mov_b32 m0, s10
    s_waitcnt lgkmcnt(0)
    s_add_u32 s48, s18, s8
    s_addc_u32 s49, s19, 0
    s_add_u32 s52, s20, s8
    s_addc_u32 s53, s21, 0
    buffer_load_dwordx4 v4, s[48:51], s64 offen offset:0 nt lds
    buffer_load_dwordx4 v5, s[48:51], s64 offen offset:1024 nt lds
    buffer_load_dwordx4 v6, s[48:51], s64 offen offset:2048 nt lds
    buffer_load_dwordx4 v7, s[48:51], s64 offen offset:3072 nt lds
    s_load_dword s47, s[42:43], 0
    v_and_b32 v120, 1, v0
    v_lshlrev_b32 v120, 4, v120
    v_bfe_u32 v121, v0, 1, 2
    v_mov_b32 v122, 0x0d0c
    v_mov_b32 v123, 0x0f0e
    v_mov_b32 v124, 0x0c0c0c0c
    v_lshlrev_b32 v122, v120, v122
    v_lshlrev_b32 v123, v120, v123
    v_xor_b32 v122, v122, v124
    v_xor_b32 v123, v123, v124
    v_cmp_eq_u32 vcc, 0, v121
    s_nop 1
    v_cndmask_b32 v16, v124, v122, vcc
    v_cndmask_b32 v20, v124, v123, vcc
    v_cmp_eq_u32 vcc, 1, v121
    s_nop 1
    v_cndmask_b32 v17, v124, v122, vcc
    v_cndmask_b32 v21, v124, v123, vcc
    v_cmp_eq_u32 vcc, 2, v121
    s_nop 1
    v_cndmask_b32 v18, v124, v122, vcc
    v_cndmask_b32 v22, v124, v123, vcc
    v_cmp_eq_u32 vcc, 3, v121
    s_nop 1
    v_cndmask_b32 v19, v124, v122, vcc
    v_cndmask_b32 v23, v124, v123, vcc
    v_xor_b32 v12, v3, v2
    v_lshlrev_b32 v12, 4, v12
    v_lshl_add_u32 v12, v3, 8, v12
    v_add_u32 v12, s10, v12
    v_xor_b32 v13, 64, v12
    v_xor_b32 v14, 0x80, v12
    v_xor_b32 v15, 0xc0, v12
    v_lshlrev_b32 v10, 8, v9
    v_lshl_add_u32 v10, v2, 4, v10
    v_lshlrev_b32 v11, 5, v9
    s_mov_b64 s[56:57], s[24:25]
    s_mov_b32 s58, 4718592
    s_mov_b32 s59, 0x20000
    s_mov_b64 s[60:61], s[32:33]
    s_cmp_lt_u32 s4, 6
    s_cselect_b32 s62, 5308416, 0
    s_mov_b32 s63, 0x20000
    s_barrier
    s_add_u32 m0, s10, 4096
    s_waitcnt vmcnt(3)
    buffer_load_dwordx4 v4, s[48:51], s65 offen offset:0 nt lds
    s_waitcnt vmcnt(3)
    buffer_load_dwordx4 v5, s[48:51], s65 offen offset:1024 nt lds
    s_waitcnt vmcnt(3)
    buffer_load_dwordx4 v6, s[48:51], s65 offen offset:2048 nt lds
    s_waitcnt vmcnt(3)
    buffer_load_dwordx4 v7, s[48:51], s65 offen offset:3072 nt lds
    s_add_u32 m0, s10, 8192
    s_waitcnt vmcnt(3)
    buffer_load_dwordx4 v4, s[48:51], s66 offen offset:0 nt lds
    s_waitcnt vmcnt(3)
    buffer_load_dwordx4 v5, s[48:51], s66 offen offset:1024 nt lds
    s_waitcnt vmcnt(3)
    buffer_load_dwordx4 v6, s[48:51], s66 offen offset:2048 nt lds
    s_waitcnt vmcnt(3)
    buffer_load_dwordx4 v7, s[48:51], s66 offen offset:3072 nt lds
    s_add_u32 m0, s10, 12288
    s_waitcnt vmcnt(3)
    buffer_load_dwordx4 v4, s[48:51], s67 offen offset:0 nt lds
    s_waitcnt vmcnt(3)
    buffer_load_dwordx4 v5, s[48:51], s67 offen offset:1024 nt lds
    s_waitcnt vmcnt(3)
    buffer_load_dwordx4 v6, s[48:51], s67 offen offset:2048 nt lds
    s_waitcnt vmcnt(3)
    buffer_load_dwordx4 v7, s[48:51], s67 offen offset:3072 nt lds
    s_waitcnt vmcnt(3)
    buffer_load_dwordx4 v[24:27], v8, s[52:55], s64 offen offset:0 nt
    s_waitcnt vmcnt(3)
    buffer_load_dwordx4 v[28:31], v8, s[52:55], s64 offen offset:256 nt
    s_waitcnt vmcnt(3)
    buffer_load_dwordx4 v[32:35], v8, s[52:55], s64 offen offset:512 nt
    s_waitcnt vmcnt(3)
    buffer_load_dwordx4 v[36:39], v8, s[52:55], s64 offen offset:768 nt
    s_waitcnt vmcnt(3)
    buffer_load_dwordx4 v[40:43], v8, s[52:55], s65 offen offset:0 nt
    s_waitcnt vmcnt(3)
    buffer_load_dwordx4 v[44:47], v8, s[52:55], s65 offen offset:256 nt
    s_waitcnt vmcnt(3)
    buffer_load_dwordx4 v[48:51], v8, s[52:55], s65 offen offset:512 nt
    s_waitcnt vmcnt(3)
    buffer_load_dwordx4 v[52:55], v8, s[52:55], s65 offen offset:768 nt
    s_waitcnt vmcnt(3)
    buffer_load_dwordx4 v[56:59], v8, s[52:55], s66 offen offset:0 nt
    s_waitcnt vmcnt(3)
    buffer_load_dwordx4 v[60:63], v8, s[52:55], s66 offen offset:256 nt
    s_waitcnt vmcnt(3)
    buffer_load_dwordx4 v[64:67], v8, s[52:55], s66 offen offset:512 nt
    s_waitcnt lgkmcnt(0)
    s_mul_i32 s47, s47, 0x9E3779B1
    s_add_u32 s47, s47, 0x7F4A7C15
    s_mov_b32 s24, 0x7060500
    s_mov_b32 s25, 0x7060501
    s_mov_b32 s26, 0x7060502
    s_mov_b32 s27, 0x7060503
    s_mov_b32 s28, 0x0c0c0400
    s_mov_b32 s29, 0x0c040100
    s_mov_b32 s30, 0x04020100
    s_mov_b32 s31, 0xffffff00
    v_mov_b32 v1, s47
    v_mov_b32 v4, 0
L_qspin:
    ds_read_b32 v5, v4 offset:1280
    ds_read_b128 v[88:91], v10 offset:0
    ds_read_b128 v[92:95], v10 offset:64
    ds_read_b128 v[96:99], v10 offset:128
    ds_read_b128 v[100:103], v10 offset:192
    s_waitcnt lgkmcnt(4)
    v_readfirstlane_b32 s72, v5
    s_cmp_eq_u32 s72, 1
    s_cbranch_scc1 L_qok
    s_sleep 2
    s_sub_u32 s75, s75, 1
    s_cmp_lg_u32 s75, 0
    s_cbranch_scc1 L_qspin
L_qok:
    ds_read_b128 v[104:107], v12 offset:0
    ds_read_b128 v[108:111], v13 offset:0
    ds_read_b128 v[112:115], v14 offset:0
    ds_read_b128 v[116:119], v15 offset:0
    s_waitcnt lgkmcnt(3)
    v_mfma_f32_16x16x32_bf16 v[120:123], v[104:107], v[88:91], 0
    s_waitcnt lgkmcnt(2)
    v_mfma_f32_16x16x32_bf16 v[120:123], v[108:111], v[92:95], v[120:123]
    s_waitcnt lgkmcnt(1)
    v_mfma_f32_16x16x32_bf16 v[120:123], v[112:115], v[96:99], v[120:123]
    s_waitcnt lgkmcnt(0)
    v_mfma_f32_16x16x32_bf16 v[120:123], v[116:119], v[100:103], v[120:123]
    ds_read_b128 v[104:107], v12 offset:4096
    ds_read_b128 v[108:111], v13 offset:4096
    ds_read_b128 v[112:115], v14 offset:4096
    ds_read_b128 v[116:119], v15 offset:4096
    s_waitcnt lgkmcnt(3)
    v_mfma_f32_16x16x32_bf16 v[124:127], v[104:107], v[88:91], 0
    s_waitcnt lgkmcnt(2)
    v_mfma_f32_16x16x32_bf16 v[124:127], v[108:111], v[92:95], v[124:127]
    s_waitcnt lgkmcnt(1)
    v_mfma_f32_16x16x32_bf16 v[124:127], v[112:115], v[96:99], v[124:127]
    s_waitcnt lgkmcnt(0)
    v_mfma_f32_16x16x32_bf16 v[124:127], v[116:119], v[100:103], v[124:127]
    s_waitcnt vmcnt(3)
    buffer_load_dwordx4 v[68:71], v8, s[52:55], s66 offen offset:768 nt
    ds_read_b128 v[104:107], v12 offset:8192
    ds_read_b128 v[108:111], v13 offset:8192
    ds_read_b128 v[112:115], v14 offset:8192
    ds_read_b128 v[116:119], v15 offset:8192
    s_waitcnt lgkmcnt(3)
    v_mfma_f32_16x16x32_bf16 v[128:131], v[104:107], v[88:91], 0
    s_waitcnt lgkmcnt(2)
    v_mfma_f32_16x16x32_bf16 v[128:131], v[108:111], v[92:95], v[128:131]
    s_waitcnt lgkmcnt(1)
    v_mfma_f32_16x16x32_bf16 v[128:131], v[112:115], v[96:99], v[128:131]
    s_waitcnt lgkmcnt(0)
    v_mfma_f32_16x16x32_bf16 v[128:131], v[116:119], v[100:103], v[128:131]
    ds_read_b128 v[104:107], v12 offset:12288
    ds_read_b128 v[108:111], v13 offset:12288
    ds_read_b128 v[112:115], v14 offset:12288
    ds_read_b128 v[116:119], v15 offset:12288
    s_waitcnt lgkmcnt(3)
    v_mfma_f32_16x16x32_bf16 v[132:135], v[104:107], v[88:91], 0
    s_waitcnt lgkmcnt(2)
    v_mfma_f32_16x16x32_bf16 v[132:135], v[108:111], v[92:95], v[132:135]
    s_waitcnt lgkmcnt(1)
    v_mfma_f32_16x16x32_bf16 v[132:135], v[112:115], v[96:99], v[132:135]
    s_waitcnt lgkmcnt(0)
    v_mfma_f32_16x16x32_bf16 v[132:135], v[116:119], v[100:103], v[132:135]
    s_nop 3
    s_waitcnt vmcnt(3)
    buffer_load_dwordx4 v[72:75], v8, s[52:55], s67 offen offset:0 nt
    v_cvt_pk_bf16_f32 v164, v120, v121
    v_lshlrev_b32 v120, 16, v164
    v_and_b32 v121, 0xffff0000, v164
    v_mul_f32 v120, 0x3db504f3, v120
    v_mul_f32 v121, 0x3db504f3, v121
    v_cvt_pk_bf16_f32 v164, v120, v121
    v_lshlrev_b32 v120, 16, v164
    v_and_b32 v121, 0xffff0000, v164
    v_cvt_pk_bf16_f32 v164, v122, v123
    v_lshlrev_b32 v122, 16, v164
    v_and_b32 v123, 0xffff0000, v164
    v_mul_f32 v122, 0x3db504f3, v122
    v_mul_f32 v123, 0x3db504f3, v123
    v_cvt_pk_bf16_f32 v164, v122, v123
    v_lshlrev_b32 v122, 16, v164
    v_and_b32 v123, 0xffff0000, v164
    v_cvt_pk_bf16_f32 v164, v124, v125
    v_lshlrev_b32 v124, 16, v164
    v_and_b32 v125, 0xffff0000, v164
    v_mul_f32 v124, 0x3db504f3, v124
    v_mul_f32 v125, 0x3db504f3, v125
    v_cvt_pk_bf16_f32 v164, v124, v125
    v_lshlrev_b32 v124, 16, v164
    v_and_b32 v125, 0xffff0000, v164
    v_cvt_pk_bf16_f32 v164, v126, v127
    v_lshlrev_b32 v126, 16, v164
    v_and_b32 v127, 0xffff0000, v164
    v_mul_f32 v126, 0x3db504f3, v126
    v_mul_f32 v127, 0x3db504f3, v127
    v_cvt_pk_bf16_f32 v164, v126, v127
    v_lshlrev_b32 v126, 16, v164
    v_and_b32 v127, 0xffff0000, v164
    v_cvt_pk_bf16_f32 v164, v128, v129
    v_lshlrev_b32 v128, 16, v164
    v_and_b32 v129, 0xffff0000, v164
    v_mul_f32 v128, 0x3db504f3, v128
    v_mul_f32 v129, 0x3db504f3, v129
    v_cvt_pk_bf16_f32 v164, v128, v129
    v_lshlrev_b32 v128, 16, v164
    v_and_b32 v129, 0xffff0000, v164
    v_cvt_pk_bf16_f32 v164, v130, v131
    v_lshlrev_b32 v130, 16, v164
    v_and_b32 v131, 0xffff0000, v164
    v_mul_f32 v130, 0x3db504f3, v130
    v_mul_f32 v131, 0x3db504f3, v131
    v_cvt_pk_bf16_f32 v164, v130, v131
    v_lshlrev_b32 v130, 16, v164
    v_and_b32 v131, 0xffff0000, v164
    v_cvt_pk_bf16_f32 v164, v132, v133
    v_lshlrev_b32 v132, 16, v164
    v_and_b32 v133, 0xffff0000, v164
    v_mul_f32 v132, 0x3db504f3, v132
    v_mul_f32 v133, 0x3db504f3, v133
    v_cvt_pk_bf16_f32 v164, v132, v133
    v_lshlrev_b32 v132, 16, v164
    v_and_b32 v133, 0xffff0000, v164
    v_cvt_pk_bf16_f32 v164, v134, v135
    v_lshlrev_b32 v134, 16, v164
    v_and_b32 v135, 0xffff0000, v164
    v_mul_f32 v134, 0x3db504f3, v134
    v_mul_f32 v135, 0x3db504f3, v135
    v_cvt_pk_bf16_f32 v164, v134, v135
    v_lshlrev_b32 v134, 16, v164
    v_and_b32 v135, 0xffff0000, v164
    s_waitcnt vmcnt(3)
    buffer_load_dwordx4 v[76:79], v8, s[52:55], s67 offen offset:256 nt
    v_max3_f32 v164, v120, v121, v122
    v_max3_f32 v164, v164, v123, v124
    v_max3_f32 v164, v164, v125, v126
    v_max3_f32 v164, v164, v127, v128
    v_max3_f32 v164, v164, v129, v130
    v_max3_f32 v164, v164, v131, v132
    v_max3_f32 v164, v164, v133, v134
    v_max_f32 v164, v164, v135
    v_mov_b32 v165, v164
    s_nop 1
    v_permlane16_swap_b32 v164, v165
    s_nop 1
    v_max_f32 v164, v164, v165
    v_mov_b32 v165, v164
    s_nop 1
    v_permlane32_swap_b32 v164, v165
    s_nop 1
    v_max_f32 v164, v164, v165
    s_lshl_b32 s11, s4, 2
    v_add_u32 v167, s11, v11
    s_mov_b32 s72, 0x3fb8aa3b
    v_mul_f32 v165, 0xbfb8aa3b, v164
    v_fma_f32 v120, v120, s72, v165
    v_fma_f32 v121, v121, s72, v165
    v_fma_f32 v122, v122, s72, v165
    v_fma_f32 v123, v123, s72, v165
    v_fma_f32 v124, v124, s72, v165
    v_fma_f32 v125, v125, s72, v165
    v_fma_f32 v126, v126, s72, v165
    v_fma_f32 v127, v127, s72, v165
    v_fma_f32 v128, v128, s72, v165
    v_fma_f32 v129, v129, s72, v165
    v_fma_f32 v130, v130, s72, v165
    v_fma_f32 v131, v131, s72, v165
    v_fma_f32 v132, v132, s72, v165
    v_fma_f32 v133, v133, s72, v165
    v_fma_f32 v134, v134, s72, v165
    v_fma_f32 v135, v135, s72, v165
    v_exp_f32 v120, v120
    v_exp_f32 v121, v121
    v_exp_f32 v122, v122
    v_exp_f32 v123, v123
    v_exp_f32 v124, v124
    v_exp_f32 v125, v125
    v_exp_f32 v126, v126
    v_exp_f32 v127, v127
    v_exp_f32 v128, v128
    v_exp_f32 v129, v129
    v_exp_f32 v130, v130
    v_exp_f32 v131, v131
    v_exp_f32 v132, v132
    v_exp_f32 v133, v133
    v_exp_f32 v134, v134
    v_exp_f32 v135, v135
    s_nop 0
    v_cvt_pk_bf16_f32 v136, v120, v121
    v_cvt_pk_bf16_f32 v137, v122, v123
    v_cvt_pk_bf16_f32 v138, v124, v125
    v_cvt_pk_bf16_f32 v139, v126, v127
    v_cvt_pk_bf16_f32 v140, v128, v129
    v_cvt_pk_bf16_f32 v141, v130, v131
    v_cvt_pk_bf16_f32 v142, v132, v133
    v_cvt_pk_bf16_f32 v143, v134, v135
    v_add_f32 v166, v120, v121
    v_add_f32 v166, v166, v122
    v_add_f32 v166, v166, v123
    v_add_f32 v166, v166, v124
    v_add_f32 v166, v166, v125
    v_add_f32 v166, v166, v126
    v_add_f32 v166, v166, v127
    v_add_f32 v166, v166, v128
    v_add_f32 v166, v166, v129
    v_add_f32 v166, v166, v130
    v_add_f32 v166, v166, v131
    v_add_f32 v166, v166, v132
    v_add_f32 v166, v166, v133
    v_add_f32 v166, v166, v134
    v_add_f32 v166, v166, v135
    v_mov_b32 v165, v166
    s_nop 1
    v_permlane16_swap_b32 v166, v165
    s_nop 1
    v_add_f32 v166, v166, v165
    v_mov_b32 v165, v166
    s_nop 1
    v_permlane32_swap_b32 v166, v165
    s_nop 1
    v_add_f32 v166, v166, v165
    s_mov_b64 exec, 0x101
    ds_write_b32 v167, v164 offset:1152
    ds_write_b32 v167, v166 offset:1216
    s_mov_b64 exec, -1
    s_waitcnt vmcnt(3)
    buffer_load_dwordx4 v[80:83], v8, s[52:55], s67 offen offset:512 nt
    s_mov_b64 s[48:49], s[42:43]
    s_mov_b32 s50, 4194304
    s_mov_b32 s51, 0x20000
    s_lshl_b32 s72, s4, 10
    v_lshlrev_b32 v122, 4, v0
    v_add_u32 v120, s72, v122
    s_and_b32 s72, s4, 1
    s_lshl_b32 s73, s72, 9
    v_and_b32 v121, 1, v0
    v_lshlrev_b32 v121, 8, v121
    v_bfe_u32 v4, v0, 1, 4
    v_lshl_add_u32 v121, v4, 4, v121
    v_add_u32 v121, s73, v121
    s_lshl_b32 s12, s7, 1
    s_add_u32 s12, s12, s72
    s_lshl_b32 s12, s12, 1
    s_add_u32 s12, s12, s44
    s_lshl_b32 s12, s12, 3
    s_add_u32 s12, s12, s45
    s_mul_i32 s12, s12, 640
    s_add_u32 s12, s12, 1048576
    s_lshl_b32 s13, s72, 5
    v_mov_b32 v7, s13
    s_movk_i32 s72, 640
    v_and_b32 v4, 3, v0
    v_lshlrev_b32 v4, 4, v4
    v_lshrrev_b32 v5, 2, v0
    v_mad_u32_u24 v123, v5, s72, v4
    s_mul_i32 s14, s46, 10240
    s_add_u32 s14, s14, 1048576
    s_lshl_b32 s15, s4, 6
    s_add_u32 s15, s15, s14
    v_lshlrev_b32 v129, 7, v9
    v_lshl_add_u32 v129, v2, 2, v129
    v_add_u32 v130, 64, v129
    s_mul_i32 s72, s4, 48
    v_mul_u32_u24 v126, 12, v2
    s_movk_i32 s73, 288
    v_mad_u32_u24 v126, v9, s73, v126
    v_add_u32 v126, s72, v126
    v_lshrrev_b32 v5, 3, v0
    v_lshlrev_b32 v128, 12, v5
    v_and_b32 v6, 7, v0
    v_lshl_add_u32 v128, v6, 4, v128
    v_cmp_lt_u32 vcc, 17, v0
    v_add_u32 v5, 46, v0
    s_nop 0
    v_cndmask_b32 v4, v0, v5, vcc
    v_lshrrev_b32 v5, 1, v4
    v_lshlrev_b32 v127, 4, v5
    v_and_b32 v5, 1, v4
    v_lshl_add_u32 v127, v5, 8, v127
    v_and_b32 v127, 0x3ff, v127
    s_mul_i32 s16, s45, 20480
    s_lshl_b32 s73, s46, 7
    s_add_u32 s16, s16, s73
    s_add_u32 s16, s16, 2097152
    s_mov_b64 s[68:69], s[34:35]
    s_mov_b32 s70, 1152
    s_mov_b32 s71, 0x20000
    s_lshl_b32 s6, s45, 2
    s_sub_u32 s6, s46, s6
    s_and_b32 s6, s6, 31
    s_cmp_eq_u32 s4, 4
    s_cselect_b32 s70, s70, 0
    s_cmp_lt_u32 s6, 5
    s_cselect_b32 s70, s70, 0
    s_lshl_b32 s72, s6, 6
    v_lshl_add_u32 v5, v6, 3, s72
    v_cmp_lt_u32 vcc, 0x8f, v5
    v_subrev_u32 v6, 0x90, v5
    v_mov_b32 v4, 0
    v_cndmask_b32 v5, v5, v6, vcc
    v_mov_b32 v6, 8
    v_cndmask_b32 v124, v4, v6, vcc
    s_mul_i32 s21, s45, 144
    buffer_load_dwordx2 v[132:133], v5, s[68:71], s21 offen
    v_mul_u32_u24 v6, 0x90, v124
    v_add_u32 v131, v5, v6
    s_mul_i32 s17, s45, 5
    s_add_u32 s17, s17, s6
    s_lshl_b32 s17, s17, 12
    s_add_u32 s17, s17, 2097152
    v_lshrrev_b32 v125, 5, v0
    v_lshlrev_b32 v125, 3, v125
    s_movk_i32 s72, 4608
    v_lshlrev_b32 v4, 4, v3
    v_mad_u32_u24 v5, v2, s72, v4
    s_movk_i32 s72, 6912
    v_mad_u32_u24 v6, v2, s72, v4
    s_lshl_b32 s18, s46, 3
    s_add_u32 s18, s18, s4
    s_mul_i32 s18, s18, 18432
    s_mul_i32 s73, s45, 144
    s_add_u32 s18, s18, s73
    s_mul_i32 s19, s46, 6
    s_add_u32 s19, s19, s4
    s_mul_i32 s19, s19, 27648
    s_add_u32 s19, s19, s73
    s_add_u32 s20, s19, 3456
    s_mov_b32 s22, 0x01ff01ff
    s_mov_b32 s23, 0x01ff01ff
    s_waitcnt vmcnt(3)
    buffer_load_dwordx4 v[84:87], v8, s[52:55], s67 offen offset:768 nt
    s_setprio 0
    s_mov_b64 exec, s[22:23]
    buffer_load_dwordx4 v[88:91], v5, s[56:59], s18 offen offset:0 nt
    buffer_load_dwordx4 v[92:95], v5, s[56:59], s18 offen offset:1152 nt
    s_mov_b64 exec, -1
    v_perm_b32 v144, v136, v136, v16
    v_perm_b32 v145, v136, v136, v17
    v_perm_b32 v146, v136, v136, v18
    v_perm_b32 v147, v136, v136, v19
    v_perm_b32 v148, v136, v136, v20
    v_perm_b32 v149, v136, v136, v21
    v_perm_b32 v150, v136, v136, v22
    v_perm_b32 v151, v136, v136, v23
    v_mfma_f32_16x16x32_bf16 v[152:155], v[144:147], v[24:27], 0
    v_perm_b32 v144, v137, v137, v16
    v_perm_b32 v145, v137, v137, v17
    v_perm_b32 v146, v137, v137, v18
    v_perm_b32 v147, v137, v137, v19
    v_mfma_f32_16x16x32_bf16 v[152:155], v[148:151], v[28:31], v[152:155]
    v_perm_b32 v148, v137, v137, v20
    v_perm_b32 v149, v137, v137, v21
    v_perm_b32 v150, v137, v137, v22
    v_perm_b32 v151, v137, v137, v23
    v_mfma_f32_16x16x32_bf16 v[152:155], v[144:147], v[32:35], v[152:155]
    v_perm_b32 v144, v138, v138, v16
    v_perm_b32 v145, v138, v138, v17
    v_perm_b32 v146, v138, v138, v18
    v_perm_b32 v147, v138, v138, v19
    v_mfma_f32_16x16x32_bf16 v[152:155], v[148:151], v[36:39], v[152:155]
    v_perm_b32 v148, v138, v138, v20
    v_perm_b32 v149, v138, v138, v21
    v_perm_b32 v150, v138, v138, v22
    v_perm_b32 v151, v138, v138, v23
    v_mfma_f32_16x16x32_bf16 v[152:155], v[144:147], v[40:43], v[152:155]
    v_perm_b32 v144, v139, v139, v16
    v_perm_b32 v145, v139, v139, v17
    v_perm_b32 v146, v139, v139, v18
    v_perm_b32 v147, v139, v139, v19
    v_mfma_f32_16x16x32_bf16 v[152:155], v[148:151], v[44:47], v[152:155]
    v_perm_b32 v148, v139, v139, v20
    v_perm_b32 v149, v139, v139, v21
    v_perm_b32 v150, v139, v139, v22
    v_perm_b32 v151, v139, v139, v23
    v_mfma_f32_16x16x32_bf16 v[152:155], v[144:147], v[48:51], v[152:155]
    v_perm_b32 v144, v140, v140, v16
    v_perm_b32 v145, v140, v140, v17
    v_perm_b32 v146, v140, v140, v18
    v_perm_b32 v147, v140, v140, v19
    v_mfma_f32_16x16x32_bf16 v[152:155], v[148:151], v[52:55], v[152:155]
    v_perm_b32 v148, v140, v140, v20
    v_perm_b32 v149, v140, v140, v21
    v_perm_b32 v150, v140, v140, v22
    v_perm_b32 v151, v140, v140, v23
    v_mfma_f32_16x16x32_bf16 v[152:155], v[144:147], v[56:59], v[152:155]
    v_perm_b32 v144, v141, v141, v16
    v_perm_b32 v145, v141, v141, v17
    v_perm_b32 v146, v141, v141, v18
    v_perm_b32 v147, v141, v141, v19
    v_mfma_f32_16x16x32_bf16 v[152:155], v[148:151], v[60:63], v[152:155]
    v_perm_b32 v148, v141, v141, v20
    v_perm_b32 v149, v141, v141, v21
    v_perm_b32 v150, v141, v141, v22
    v_perm_b32 v151, v141, v141, v23
    v_mfma_f32_16x16x32_bf16 v[152:155], v[144:147], v[64:67], v[152:155]
    v_perm_b32 v144, v142, v142, v16
    v_perm_b32 v145, v142, v142, v17
    v_perm_b32 v146, v142, v142, v18
    v_perm_b32 v147, v142, v142, v19
    v_mfma_f32_16x16x32_bf16 v[152:155], v[148:151], v[68:71], v[152:155]
    v_perm_b32 v148, v142, v142, v20
    v_perm_b32 v149, v142, v142, v21
    v_perm_b32 v150, v142, v142, v22
    v_perm_b32 v151, v142, v142, v23
    s_waitcnt vmcnt(5)
    v_mfma_f32_16x16x32_bf16 v[152:155], v[144:147], v[72:75], v[152:155]
    s_mov_b64 exec, s[22:23]
    buffer_load_dwordx4 v[96:99], v5, s[56:59], s18 offen offset:2304 nt
    s_mov_b64 exec, -1
    v_perm_b32 v144, v143, v143, v16
    v_perm_b32 v145, v143, v143, v17
    v_perm_b32 v146, v143, v143, v18
    v_perm_b32 v147, v143, v143, v19
    s_waitcnt vmcnt(5)
    v_mfma_f32_16x16x32_bf16 v[152:155], v[148:151], v[76:79], v[152:155]
    s_mov_b64 exec, s[22:23]
    buffer_load_dwordx4 v[100:103], v5, s[56:59], s18 offen offset:3456 nt
    s_mov_b64 exec, -1
    v_perm_b32 v148, v143, v143, v20
    v_perm_b32 v149, v143, v143, v21
    v_perm_b32 v150, v143, v143, v22
    v_perm_b32 v151, v143, v143, v23
    s_waitcnt vmcnt(5)
    v_mfma_f32_16x16x32_bf16 v[152:155], v[144:147], v[80:83], v[152:155]
    s_mov_b64 exec, s[22:23]
    buffer_load_dwordx4 v[104:107], v6, s[60:63], s19 offen offset:0 nt
    s_mov_b64 exec, -1
    s_nop 1
    s_waitcnt vmcnt(5)
    v_mfma_f32_16x16x32_bf16 v[152:155], v[148:151], v[84:87], v[152:155]
    s_mov_b64 exec, s[22:23]
    buffer_load_dwordx4 v[108:111], v6, s[60:63], s19 offen offset:1152 nt
    buffer_load_dwordx4 v[112:115], v6, s[60:63], s19 offen offset:2304 nt
    buffer_load_dwordx4 v[116:119], v6, s[60:63], s20 offen offset:0 nt
    buffer_load_dwordx4 v[156:159], v6, s[60:63], s20 offen offset:1152 nt
    buffer_load_dwordx4 v[160:163], v6, s[60:63], s20 offen offset:2304 nt
    s_mov_b64 exec, -1
    s_mov_b64 s[68:69], s[40:41]
    s_lshl_b32 s13, s7, 2
    s_add_u32 s13, s13, 128
    s_mov_b64 s[64:65], s[42:43]
    s_cmp_ge_u32 s4, 6
    s_cselect_b32 s70, 256, 0
    s_mov_b32 s71, 0x20000
    s_cselect_b32 s66, 4194304, 0
    s_mov_b32 s67, 0x20000
    s_nop 1
    ds_write_b128 v120, v[152:155] offset:7168
    s_waitcnt lgkmcnt(0)
    s_barrier
    ds_read_b64 v[134:135], v125 offset:1088
    s_cmp_lt_u32 s4, 6
    s_cbranch_scc1 L_nopub
    s_setprio 3
    ds_read_b128 v[24:27], v7 offset:1152
    ds_read_b128 v[28:31], v7 offset:1168
    ds_read_b128 v[32:35], v121 offset:7168
    ds_read_b128 v[36:39], v121 offset:8192
    ds_read_b128 v[40:43], v121 offset:9216
    ds_read_b128 v[44:47], v121 offset:10240
    ds_read_b128 v[48:51], v121 offset:11264
    ds_read_b128 v[52:55], v121 offset:12288
    ds_read_b128 v[56:59], v121 offset:13312
    ds_read_b128 v[60:63], v121 offset:14336
    ds_read_b128 v[64:67], v7 offset:1216
    ds_read_b128 v[68:71], v7 offset:1232
    s_mov_b32 s72, 0x3fb8aa3b
    s_waitcnt lgkmcnt(10)
    v_max3_f32 v165, v24, v25, v26
    v_max3_f32 v164, v27, v28, v29
    v_max3_f32 v165, v165, v30, v31
    v_max_f32 v165, v165, v164
    v_mul_f32 v164, 0xbfb8aa3b, v165
    v_fma_f32 v24, v24, s72, v164
    v_fma_f32 v25, v25, s72, v164
    v_fma_f32 v26, v26, s72, v164
    v_fma_f32 v27, v27, s72, v164
    v_fma_f32 v28, v28, s72, v164
    v_fma_f32 v29, v29, s72, v164
    v_fma_f32 v30, v30, s72, v164
    v_fma_f32 v31, v31, s72, v164
    v_exp_f32 v24, v24
    v_exp_f32 v25, v25
    v_exp_f32 v26, v26
    v_exp_f32 v27, v27
    v_exp_f32 v28, v28
    v_exp_f32 v29, v29
    v_exp_f32 v30, v30
    v_exp_f32 v31, v31
    s_waitcnt lgkmcnt(9)
    v_mul_f32 v72, v24, v32
    v_mul_f32 v73, v24, v33
    v_mul_f32 v74, v24, v34
    v_mul_f32 v75, v24, v35
    s_waitcnt lgkmcnt(8)
    v_fmac_f32 v72, v25, v36
    v_fmac_f32 v73, v25, v37
    v_fmac_f32 v74, v25, v38
    v_fmac_f32 v75, v25, v39
    s_waitcnt lgkmcnt(7)
    v_fmac_f32 v72, v26, v40
    v_fmac_f32 v73, v26, v41
    v_fmac_f32 v74, v26, v42
    v_fmac_f32 v75, v26, v43
    s_waitcnt lgkmcnt(6)
    v_fmac_f32 v72, v27, v44
    v_fmac_f32 v73, v27, v45
    v_fmac_f32 v74, v27, v46
    v_fmac_f32 v75, v27, v47
    s_waitcnt lgkmcnt(5)
    v_fmac_f32 v72, v28, v48
    v_fmac_f32 v73, v28, v49
    v_fmac_f32 v74, v28, v50
    v_fmac_f32 v75, v28, v51
    s_waitcnt lgkmcnt(4)
    v_fmac_f32 v72, v29, v52
    v_fmac_f32 v73, v29, v53
    v_fmac_f32 v74, v29, v54
    v_fmac_f32 v75, v29, v55
    s_waitcnt lgkmcnt(3)
    v_fmac_f32 v72, v30, v56
    v_fmac_f32 v73, v30, v57
    v_fmac_f32 v74, v30, v58
    v_fmac_f32 v75, v30, v59
    s_waitcnt lgkmcnt(2)
    v_fmac_f32 v72, v31, v60
    v_fmac_f32 v73, v31, v61
    v_fmac_f32 v74, v31, v62
    v_fmac_f32 v75, v31, v63
    v_perm_b32 v72, v72, v1, s24
    v_perm_b32 v73, v73, v1, s25
    v_perm_b32 v74, v74, v1, s26
    v_perm_b32 v75, v75, v1, s27
    s_waitcnt lgkmcnt(0)
    s_mov_b32 exec_lo, 0
    s_mov_b32 exec_hi, 0xff
    v_mul_f32 v74, v24, v64
    v_fmac_f32 v74, v25, v65
    v_fmac_f32 v74, v26, v66
    v_fmac_f32 v74, v27, v67
    v_fmac_f32 v74, v28, v68
    v_fmac_f32 v74, v29, v69
    v_fmac_f32 v74, v30, v70
    v_fmac_f32 v74, v31, v71
    v_mov_b32 v72, v165
    v_mov_b32 v73, v1
    v_mov_b32 v75, v1
    s_mov_b32 exec_lo, -1
    buffer_store_dwordx4 v[72:75], v122, s[48:51], s12 offen
    s_mov_b64 exec, -1
    v_mov_b32 v76, 0
    v_mov_b32 v77, 0
    v_mov_b32 v78, 0
    v_mov_b32 v79, 0
    s_cmp_eq_u32 s5, 0
    s_cbranch_scc1 L_now2
    s_mov_b64 s[8:9], exec
    s_mov_b32 exec_lo, -1
    s_mov_b32 exec_hi, 0xff
    buffer_store_dwordx4 v[72:75], v122, s[64:67], s12 offen sc1
    s_mov_b32 s66, 0
    s_mov_b64 exec, s[8:9]
    s_branch L_now2
L_nopub:
    ds_read2_b32 v[136:137], v126 offset0:128 offset1:129
    ds_read_b32 v138, v126 offset:520
    s_waitcnt lgkmcnt(0)
    v_perm_b32 v144, v136, v136, v16
    v_perm_b32 v145, v136, v136, v17
    v_perm_b32 v146, v136, v136, v18
    v_perm_b32 v147, v136, v136, v19
    v_perm_b32 v148, v136, v136, v20
    v_perm_b32 v149, v136, v136, v21
    v_perm_b32 v150, v136, v136, v22
    v_perm_b32 v151, v136, v136, v23
    s_waitcnt vmcnt(0)
    v_mfma_f32_16x16x32_bf16 v[76:79], v[144:147], v[104:107], 0
    v_perm_b32 v144, v137, v137, v16
    v_perm_b32 v145, v137, v137, v17
    v_perm_b32 v146, v137, v137, v18
    v_perm_b32 v147, v137, v137, v19
    v_mfma_f32_16x16x32_bf16 v[76:79], v[148:151], v[108:111], v[76:79]
    v_perm_b32 v148, v137, v137, v20
    v_perm_b32 v149, v137, v137, v21
    v_perm_b32 v150, v137, v137, v22
    v_perm_b32 v151, v137, v137, v23
    v_mfma_f32_16x16x32_bf16 v[76:79], v[144:147], v[112:115], v[76:79]
    v_perm_b32 v144, v138, v138, v16
    v_perm_b32 v145, v138, v138, v17
    v_perm_b32 v146, v138, v138, v18
    v_perm_b32 v147, v138, v138, v19
    v_mfma_f32_16x16x32_bf16 v[76:79], v[148:151], v[116:119], v[76:79]
    v_perm_b32 v148, v138, v138, v20
    v_perm_b32 v149, v138, v138, v21
    v_perm_b32 v150, v138, v138, v22
    v_perm_b32 v151, v138, v138, v23
    v_mfma_f32_16x16x32_bf16 v[76:79], v[144:147], v[156:159], v[76:79]
    s_nop 1
    v_mfma_f32_16x16x32_bf16 v[76:79], v[148:151], v[160:163], v[76:79]
    s_nop 7
    v_mul_f32 v76, v135, v76
    v_mul_f32 v77, v135, v77
    v_mul_f32 v78, v135, v78
    v_mul_f32 v79, v135, v79
L_now2:
    v_mov_b32 v7, 0
    s_or_b32 s75, s75, 31
    buffer_load_dwordx4 v[24:27], v123, s[48:51], s15 offen sc1 nt
    buffer_load_dwordx4 v[28:31], v123, s[48:51], s14 offen offset:512 sc1 nt
L_poll_1:
    s_waitcnt vmcnt(0)
    s_mov_b64 exec, -1
    v_cmpx_eq_u32 vcc, s47, v29
    v_cmpx_eq_u32 vcc, s47, v31
    v_perm_b32 v32, v25, v24, s28
    v_perm_b32 v32, v26, v32, s29
    v_perm_b32 v32, v27, v32, s30
    v_cmpx_eq_u32 vcc, s47, v32
    s_nop 1
    s_andn2_b64 exec, -1, exec
    s_cbranch_scc0 L_ok_1
    s_bcnt1_i32_b64 s74, exec
    s_sleep 1
    s_cmp_lt_u32 s74, 16
    s_cbranch_scc1 L_ns_1
    s_sleep 4
L_ns_1:
    buffer_load_dwordx4 v[24:27], v123, s[48:51], s15 offen sc1 nt
    buffer_load_dwordx4 v[28:31], v123, s[48:51], s14 offen offset:512 sc1 nt
    s_and_b32 s74, s75, 31
    s_cbranch_scc1 L_nf_1
    s_mov_b64 s[8:9], exec
    s_mov_b32 exec_lo, -1
    s_mov_b32 exec_hi, 0xff
    buffer_store_dwordx4 v[72:75], v122, s[64:67], s12 offen sc1
    s_mov_b32 s66, 0
    s_mov_b64 exec, s[8:9]
L_nf_1:
    s_sub_u32 s75, s75, 1
    s_cmp_lg_u32 s75, 0
    s_cbranch_scc1 L_poll_1
    s_waitcnt vmcnt(0)
L_ok_1:
    s_mov_b64 exec, -1
    buffer_load_dword v166, v7, s[68:71], s13 offen sc1
    s_nop 2
    v_max_f32_dpp v32, v28, v28 row_ror:4 row_mask:0xf bank_mask:0xf
    s_nop 1
    v_max_f32_dpp v32, v32, v32 row_ror:8 row_mask:0xf bank_mask:0xf
    v_mov_b32 v35, v32
    s_nop 1
    v_permlane16_swap_b32 v32, v35
    s_nop 1
    v_max_f32 v32, v32, v35
    v_sub_f32 v33, v28, v32
    v_mul_f32 v33, 0x3fb8aa3b, v33
    v_exp_f32 v33, v33
    v_and_b32 v24, s31, v24
    v_and_b32 v25, s31, v25
    v_and_b32 v26, s31, v26
    v_and_b32 v27, s31, v27
    v_mul_f32 v34, v33, v30
    v_mul_f32 v24, v33, v24
    v_mul_f32 v25, v33, v25
    v_mul_f32 v26, v33, v26
    v_mul_f32 v27, v33, v27
    v_add_f32_dpp v34, v34, v34 row_ror:4 row_mask:0xf bank_mask:0xf
    v_add_f32_dpp v24, v24, v24 row_ror:4 row_mask:0xf bank_mask:0xf
    v_add_f32_dpp v25, v25, v25 row_ror:4 row_mask:0xf bank_mask:0xf
    v_add_f32_dpp v26, v26, v26 row_ror:4 row_mask:0xf bank_mask:0xf
    v_add_f32_dpp v27, v27, v27 row_ror:4 row_mask:0xf bank_mask:0xf
    v_add_f32_dpp v34, v34, v34 row_ror:8 row_mask:0xf bank_mask:0xf
    v_add_f32_dpp v24, v24, v24 row_ror:8 row_mask:0xf bank_mask:0xf
    v_add_f32_dpp v25, v25, v25 row_ror:8 row_mask:0xf bank_mask:0xf
    v_add_f32_dpp v26, v26, v26 row_ror:8 row_mask:0xf bank_mask:0xf
    v_add_f32_dpp v27, v27, v27 row_ror:8 row_mask:0xf bank_mask:0xf
    v_mov_b32 v35, v34
    s_nop 0
    v_permlane16_swap_b32 v24, v26
    v_permlane16_swap_b32 v25, v27
    v_permlane16_swap_b32 v34, v35
    v_add_f32 v24, v24, v26
    v_add_f32 v25, v25, v27
    v_add_f32 v34, v34, v35
    v_rcp_f32 v34, v34
    s_nop 0
    v_mul_f32 v24, v34, v24
    v_mul_f32 v25, v34, v25
    v_cvt_pk_bf16_f32 v24, v24, v25
    ds_bpermute_b32 v136, v129, v24
    ds_bpermute_b32 v137, v130, v24
    s_waitcnt lgkmcnt(0)
    v_perm_b32 v144, v136, v136, v16
    v_perm_b32 v145, v136, v136, v17
    v_perm_b32 v146, v136, v136, v18
    v_perm_b32 v147, v136, v136, v19
    v_perm_b32 v148, v136, v136, v20
    v_perm_b32 v149, v136, v136, v21
    v_perm_b32 v150, v136, v136, v22
    v_perm_b32 v151, v136, v136, v23
    v_mfma_f32_16x16x32_bf16 v[80:83], v[144:147], v[88:91], 0
    v_perm_b32 v144, v137, v137, v16
    v_perm_b32 v145, v137, v137, v17
    v_perm_b32 v146, v137, v137, v18
    v_perm_b32 v147, v137, v137, v19
    v_mfma_f32_16x16x32_bf16 v[80:83], v[148:151], v[92:95], v[80:83]
    v_perm_b32 v148, v137, v137, v20
    v_perm_b32 v149, v137, v137, v21
    v_perm_b32 v150, v137, v137, v22
    v_perm_b32 v151, v137, v137, v23
    v_mfma_f32_16x16x32_bf16 v[80:83], v[144:147], v[96:99], v[80:83]
    s_nop 1
    v_mfma_f32_16x16x32_bf16 v[80:83], v[148:151], v[100:103], v[80:83]
    s_nop 7
    v_fmac_f32 v76, v134, v80
    v_fmac_f32 v77, v134, v81
    v_fmac_f32 v78, v134, v82
    v_fmac_f32 v79, v134, v83
    ds_write_b128 v120, v[76:79] offset:15360
    s_waitcnt lgkmcnt(0)
    s_barrier
    s_cmp_ge_u32 s4, 1
    s_cbranch_scc1 L_final
    ds_read_b128 v[32:35], v127 offset:15360
    ds_read_b128 v[36:39], v127 offset:16384
    ds_read_b128 v[40:43], v127 offset:17408
    ds_read_b128 v[44:47], v127 offset:18432
    ds_read_b128 v[48:51], v127 offset:19456
    ds_read_b128 v[52:55], v127 offset:20480
    ds_read_b128 v[56:59], v127 offset:21504
    ds_read_b128 v[60:63], v127 offset:22528
    s_mov_b32 exec_hi, 0xff
    s_waitcnt lgkmcnt(6)
    v_add_f32 v24, v32, v36
    v_add_f32 v25, v33, v37
    v_add_f32 v26, v34, v38
    v_add_f32 v27, v35, v39
    s_waitcnt lgkmcnt(5)
    v_add_f32 v24, v24, v40
    v_add_f32 v25, v25, v41
    v_add_f32 v26, v26, v42
    v_add_f32 v27, v27, v43
    s_waitcnt lgkmcnt(4)
    v_add_f32 v24, v24, v44
    v_add_f32 v25, v25, v45
    v_add_f32 v26, v26, v46
    v_add_f32 v27, v27, v47
    s_waitcnt lgkmcnt(3)
    v_add_f32 v24, v24, v48
    v_add_f32 v25, v25, v49
    v_add_f32 v26, v26, v50
    v_add_f32 v27, v27, v51
    s_waitcnt lgkmcnt(2)
    v_add_f32 v24, v24, v52
    v_add_f32 v25, v25, v53
    v_add_f32 v26, v26, v54
    v_add_f32 v27, v27, v55
    s_waitcnt lgkmcnt(1)
    v_add_f32 v24, v24, v56
    v_add_f32 v25, v25, v57
    v_add_f32 v26, v26, v58
    v_add_f32 v27, v27, v59
    s_waitcnt lgkmcnt(0)
    v_add_f32 v24, v24, v60
    v_add_f32 v25, v25, v61
    v_add_f32 v26, v26, v62
    v_add_f32 v27, v27, v63
    v_perm_b32 v24, v24, v1, s24
    v_perm_b32 v25, v25, v1, s25
    v_perm_b32 v26, v26, v1, s26
    v_perm_b32 v27, v27, v1, s27
    buffer_store_dwordx4 v[24:27], v128, s[48:51], s16 offen sc1
    s_endpgm
L_final:
    s_cmp_lt_u32 s4, 6
    s_cbranch_scc1 L_nohelp
    s_waitcnt vmcnt(0)
    v_readfirstlane_b32 s10, v166
    s_cmp_eq_u32 s10, 0
    s_cbranch_scc1 L_nohelp
    s_mov_b64 s[8:9], exec
    s_mov_b32 exec_lo, -1
    s_mov_b32 exec_hi, 0xff
    buffer_store_dwordx4 v[72:75], v122, s[64:67], s12 offen sc1
    s_mov_b32 s66, 0
    s_mov_b64 exec, s[8:9]
L_nohelp:
    s_cmp_lg_u32 s4, 4
    s_cbranch_scc1 L_end
    s_cmp_ge_u32 s6, 5
    s_cbranch_scc1 L_end
    buffer_load_dwordx4 v[24:27], v122, s[48:51], s17 offen offset:0 sc1
    buffer_load_dwordx4 v[28:31], v122, s[48:51], s17 offen offset:1024 sc1
    buffer_load_dwordx4 v[32:35], v122, s[48:51], s17 offen offset:2048 sc1
    buffer_load_dwordx4 v[36:39], v122, s[48:51], s17 offen offset:3072 sc1
    ds_read_b64 v[42:43], v124 offset:1088
    s_mov_b64 s[56:57], s[38:39]
    s_mov_b32 s58, 2304
    s_mov_b32 s59, 0x20000
    s_cmp_eq_u32 s6, 4
    s_cselect_b64 s[10:11], 0xf, 0xff
    s_waitcnt lgkmcnt(0)
    v_lshlrev_b32 v76, 16, v132
    v_and_b32 v77, 0xffff0000, v132
    v_lshlrev_b32 v78, 16, v133
    v_and_b32 v79, 0xffff0000, v133
    v_mul_f32 v76, v43, v76
    v_mul_f32 v77, v43, v77
    v_mul_f32 v78, v43, v78
    v_mul_f32 v79, v43, v79
L_poll_2:
    s_waitcnt vmcnt(0)
    s_mov_b64 exec, -1
    v_perm_b32 v44, v25, v24, s28
    v_perm_b32 v44, v26, v44, s29
    v_perm_b32 v44, v27, v44, s30
    v_cmpx_eq_u32 vcc, s47, v44
    v_perm_b32 v44, v29, v28, s28
    v_perm_b32 v44, v30, v44, s29
    v_perm_b32 v44, v31, v44, s30
    v_cmpx_eq_u32 vcc, s47, v44
    v_perm_b32 v44, v33, v32, s28
    v_perm_b32 v44, v34, v44, s29
    v_perm_b32 v44, v35, v44, s30
    v_cmpx_eq_u32 vcc, s47, v44
    v_perm_b32 v44, v37, v36, s28
    v_perm_b32 v44, v38, v44, s29
    v_perm_b32 v44, v39, v44, s30
    v_cmpx_eq_u32 vcc, s47, v44
    s_nop 1
    s_andn2_b64 exec, -1, exec
    s_cbranch_scc0 L_ok_2
    s_bcnt1_i32_b64 s74, exec
    s_sleep 1
    s_cmp_lt_u32 s74, 24
    s_cbranch_scc1 L_ns_2
    s_sleep 4
L_ns_2:
    buffer_load_dwordx4 v[24:27], v122, s[48:51], s17 offen offset:0 sc1
    buffer_load_dwordx4 v[28:31], v122, s[48:51], s17 offen offset:1024 sc1
    buffer_load_dwordx4 v[32:35], v122, s[48:51], s17 offen offset:2048 sc1
    buffer_load_dwordx4 v[36:39], v122, s[48:51], s17 offen offset:3072 sc1
    s_sub_u32 s75, s75, 1
    s_cmp_lg_u32 s75, 0
    s_cbranch_scc1 L_poll_2
    s_waitcnt vmcnt(0)
L_ok_2:
    s_mov_b64 exec, -1
    v_and_b32 v24, s31, v24
    v_and_b32 v25, s31, v25
    v_and_b32 v26, s31, v26
    v_and_b32 v27, s31, v27
    v_and_b32 v28, s31, v28
    v_and_b32 v29, s31, v29
    v_and_b32 v30, s31, v30
    v_and_b32 v31, s31, v31
    v_and_b32 v32, s31, v32
    v_and_b32 v33, s31, v33
    v_and_b32 v34, s31, v34
    v_and_b32 v35, s31, v35
    v_and_b32 v36, s31, v36
    v_and_b32 v37, s31, v37
    v_and_b32 v38, s31, v38
    v_and_b32 v39, s31, v39
    v_add_f32 v24, v24, v28
    v_add_f32 v25, v25, v29
    v_add_f32 v26, v26, v30
    v_add_f32 v27, v27, v31
    v_add_f32 v24, v24, v32
    v_add_f32 v25, v25, v33
    v_add_f32 v26, v26, v34
    v_add_f32 v27, v27, v35
    v_add_f32 v24, v24, v36
    v_add_f32 v25, v25, v37
    v_add_f32 v26, v26, v38
    v_add_f32 v27, v27, v39
    v_add_f32_dpp v24, v24, v24 row_ror:8 row_mask:0xf bank_mask:0xf
    v_add_f32_dpp v25, v25, v25 row_ror:8 row_mask:0xf bank_mask:0xf
    v_add_f32_dpp v26, v26, v26 row_ror:8 row_mask:0xf bank_mask:0xf
    v_add_f32_dpp v27, v27, v27 row_ror:8 row_mask:0xf bank_mask:0xf
    v_mov_b32 v28, v24
    v_mov_b32 v29, v25
    v_mov_b32 v30, v26
    v_mov_b32 v31, v27
    v_permlane16_swap_b32 v24, v28
    v_permlane16_swap_b32 v25, v29
    v_permlane16_swap_b32 v26, v30
    v_permlane16_swap_b32 v27, v31
    v_add_f32 v24, v24, v28
    v_add_f32 v25, v25, v29
    v_add_f32 v26, v26, v30
    v_add_f32 v27, v27, v31
    v_mov_b32 v28, v24
    v_mov_b32 v29, v25
    v_mov_b32 v30, v26
    v_mov_b32 v31, v27
    v_permlane32_swap_b32 v24, v28
    v_permlane32_swap_b32 v25, v29
    v_permlane32_swap_b32 v26, v30
    v_permlane32_swap_b32 v27, v31
    v_add_f32 v24, v24, v28
    v_add_f32 v25, v25, v29
    v_add_f32 v26, v26, v30
    v_add_f32 v27, v27, v31
    v_add_f32 v24, v24, v76
    v_add_f32 v25, v25, v77
    v_add_f32 v26, v26, v78
    v_add_f32 v27, v27, v79
    v_cvt_pk_bf16_f32 v24, v24, v25
    v_cvt_pk_bf16_f32 v25, v26, v27
    s_mov_b64 exec, s[10:11]
    buffer_store_dwordx2 v[24:25], v131, s[56:59], s21 offen
    s_or_b32 s8, s45, s6
    s_cmp_lg_u32 s8, 0
    s_cbranch_scc1 L_fin2
    s_mov_b64 exec, 1
    buffer_store_dword v1, v7, s[48:51], 0 offen sc1
L_fin2:
    s_endpgm
L_s0b:
    v_mov_b32 v149, v5
    v_and_b32 v6, 31, v0
    v_mul_u32_u24 v8, 36, v6
    v_lshrrev_b32 v7, 5, v0
    s_movk_i32 s8, 1152
    v_mad_u32_u24 v11, v7, s8, v8
    v_and_b32 v144, 1, v0
    v_lshlrev_b32 v144, 4, v144
    v_bfe_u32 v145, v0, 1, 2
    v_mov_b32 v146, 0x0d0c
    v_mov_b32 v147, 0x0f0e
    v_mov_b32 v148, 0x0c0c0c0c
    v_lshlrev_b32 v146, v144, v146
    v_lshlrev_b32 v147, v144, v147
    v_xor_b32 v146, v146, v148
    v_xor_b32 v147, v147, v148
    v_cmp_eq_u32 vcc, 0, v145
    s_nop 1
    v_cndmask_b32 v16, v148, v146, vcc
    v_cndmask_b32 v20, v148, v147, vcc
    v_cmp_eq_u32 vcc, 1, v145
    s_nop 1
    v_cndmask_b32 v17, v148, v146, vcc
    v_cndmask_b32 v21, v148, v147, vcc
    v_cmp_eq_u32 vcc, 2, v145
    s_nop 1
    v_cndmask_b32 v18, v148, v146, vcc
    v_cndmask_b32 v22, v148, v147, vcc
    v_cmp_eq_u32 vcc, 3, v145
    s_nop 1
    v_cndmask_b32 v19, v148, v146, vcc
    v_cndmask_b32 v23, v148, v147, vcc
    s_mov_b64 s[60:61], s[42:43]
    s_mov_b32 s62, 4194304
    s_mov_b32 s63, 0x20000
    v_lshlrev_b32 v10, 13, v7
    v_lshl_add_u32 v10, v6, 4, v10
    s_lshl_b32 s10, s7, 14
    s_lshl_b32 s11, s45, 10
    s_add_u32 s11, s11, s10
    s_lshl_b32 s8, s44, 9
    s_add_u32 s11, s11, s8
    s_add_u32 s11, s11, 4096
    s_lshl_b32 s8, s44, 13
    s_add_u32 s64, s10, s8
    s_add_u32 s64, s64, 4096
    s_add_u32 s65, s64, 4096
    v_lshlrev_b32 v12, 4, v0
    v_lshlrev_b32 v13, 9, v0
    v_lshlrev_b32 v14, 4, v3
    v_and_b32 v15, 1, v2
    v_lshl_add_u32 v14, v15, 3, v14
    v_lshl_add_u32 v14, v7, 8, v14
    s_mov_b64 s[68:69], s[40:41]
    s_mov_b32 s70, 256
    s_mov_b32 s71, 0x20000
    s_lshl_b32 s13, s7, 2
    s_add_u32 s13, s13, 128
    s_cmp_eq_u32 s5, 0
    s_cbranch_scc1 L_placed
    v_mov_b32 v150, 0
    v_mov_b32 v5, 1
    buffer_store_dword v5, v150, s[68:71], s13 offen sc1
    s_waitcnt vmcnt(0)
L_placed:
    s_waitcnt lgkmcnt(0) vmcnt(18)
    s_barrier
    s_add_u32 s9, s9, 2048
    v_add_u32 v4, s9, v4
    ds_read2_b32 v[24:25], v4 offset0:0 offset1:1
    ds_read2_b32 v[26:27], v4 offset0:2 offset1:3
    ds_read2_b32 v[28:29], v4 offset0:4 offset1:5
    ds_read2_b32 v[30:31], v4 offset0:6 offset1:7
    ds_read_b32 v32, v4 offset:32
    ds_read_b32 v124, v11 offset:2048
    ds_read_b32 v125, v11 offset:2052
    ds_read_b32 v126, v11 offset:2056
    ds_read_b32 v127, v11 offset:2060
    ds_read_b32 v128, v11 offset:2064
    ds_read_b32 v129, v11 offset:2068
    ds_read_b32 v130, v11 offset:2072
    ds_read_b32 v131, v11 offset:2076
    ds_read_b32 v132, v11 offset:2080
    s_waitcnt lgkmcnt(9)
    ds_read_b32 v134, v8 offset:5120
    ds_read_b32 v135, v8 offset:5124
    ds_read_b32 v136, v8 offset:5128
    ds_read_b32 v137, v8 offset:5132
    ds_read_b32 v138, v8 offset:5136
    s_waitcnt lgkmcnt(5)
    ds_read_b32 v139, v8 offset:5140
    ds_read_b32 v140, v8 offset:5144
    ds_read_b32 v141, v8 offset:5148
    ds_read_b32 v142, v8 offset:5152
    s_waitcnt lgkmcnt(0)
    s_load_dword s47, s[42:43], 0
    v_perm_b32 v112, v24, v24, v16
    v_perm_b32 v113, v24, v24, v17
    v_perm_b32 v114, v24, v24, v18
    v_perm_b32 v115, v24, v24, v19
    v_perm_b32 v116, v24, v24, v20
    v_perm_b32 v117, v24, v24, v21
    v_perm_b32 v118, v24, v24, v22
    v_perm_b32 v119, v24, v24, v23
    s_waitcnt vmcnt(17)
    v_mfma_f32_16x16x32_bf16 v[120:123], v[112:115], v[40:43], 0
    v_perm_b32 v112, v25, v25, v16
    v_perm_b32 v113, v25, v25, v17
    v_perm_b32 v114, v25, v25, v18
    v_perm_b32 v115, v25, v25, v19
    s_waitcnt vmcnt(16)
    v_mfma_f32_16x16x32_bf16 v[120:123], v[116:119], v[44:47], v[120:123]
    v_perm_b32 v116, v25, v25, v20
    v_perm_b32 v117, v25, v25, v21
    v_perm_b32 v118, v25, v25, v22
    v_perm_b32 v119, v25, v25, v23
    s_waitcnt vmcnt(15)
    v_mfma_f32_16x16x32_bf16 v[120:123], v[112:115], v[48:51], v[120:123]
    v_perm_b32 v112, v26, v26, v16
    v_perm_b32 v113, v26, v26, v17
    v_perm_b32 v114, v26, v26, v18
    v_perm_b32 v115, v26, v26, v19
    s_waitcnt vmcnt(14)
    v_mfma_f32_16x16x32_bf16 v[120:123], v[116:119], v[52:55], v[120:123]
    v_perm_b32 v116, v26, v26, v20
    v_perm_b32 v117, v26, v26, v21
    v_perm_b32 v118, v26, v26, v22
    v_perm_b32 v119, v26, v26, v23
    s_waitcnt vmcnt(13)
    v_mfma_f32_16x16x32_bf16 v[120:123], v[112:115], v[56:59], v[120:123]
    v_perm_b32 v112, v27, v27, v16
    v_perm_b32 v113, v27, v27, v17
    v_perm_b32 v114, v27, v27, v18
    v_perm_b32 v115, v27, v27, v19
    s_waitcnt vmcnt(12)
    v_mfma_f32_16x16x32_bf16 v[120:123], v[116:119], v[60:63], v[120:123]
    v_perm_b32 v116, v27, v27, v20
    v_perm_b32 v117, v27, v27, v21
    v_perm_b32 v118, v27, v27, v22
    v_perm_b32 v119, v27, v27, v23
    s_waitcnt vmcnt(11)
    v_mfma_f32_16x16x32_bf16 v[120:123], v[112:115], v[64:67], v[120:123]
    v_perm_b32 v112, v28, v28, v16
    v_perm_b32 v113, v28, v28, v17
    v_perm_b32 v114, v28, v28, v18
    v_perm_b32 v115, v28, v28, v19
    s_waitcnt vmcnt(10)
    v_mfma_f32_16x16x32_bf16 v[120:123], v[116:119], v[68:71], v[120:123]
    v_perm_b32 v116, v28, v28, v20
    v_perm_b32 v117, v28, v28, v21
    v_perm_b32 v118, v28, v28, v22
    v_perm_b32 v119, v28, v28, v23
    s_waitcnt vmcnt(9)
    v_mfma_f32_16x16x32_bf16 v[120:123], v[112:115], v[72:75], v[120:123]
    v_perm_b32 v112, v29, v29, v16
    v_perm_b32 v113, v29, v29, v17
    v_perm_b32 v114, v29, v29, v18
    v_perm_b32 v115, v29, v29, v19
    s_waitcnt vmcnt(8)
    v_mfma_f32_16x16x32_bf16 v[120:123], v[116:119], v[76:79], v[120:123]
    v_perm_b32 v116, v29, v29, v20
    v_perm_b32 v117, v29, v29, v21
    v_perm_b32 v118, v29, v29, v22
    v_perm_b32 v119, v29, v29, v23
    s_waitcnt vmcnt(7)
    v_mfma_f32_16x16x32_bf16 v[120:123], v[112:115], v[80:83], v[120:123]
    v_perm_b32 v112, v30, v30, v16
    v_perm_b32 v113, v30, v30, v17
    v_perm_b32 v114, v30, v30, v18
    v_perm_b32 v115, v30, v30, v19
    s_waitcnt vmcnt(6)
    v_mfma_f32_16x16x32_bf16 v[120:123], v[116:119], v[84:87], v[120:123]
    v_perm_b32 v116, v30, v30, v20
    v_perm_b32 v117, v30, v30, v21
    v_perm_b32 v118, v30, v30, v22
    v_perm_b32 v119, v30, v30, v23
    s_waitcnt vmcnt(5)
    v_mfma_f32_16x16x32_bf16 v[120:123], v[112:115], v[88:91], v[120:123]
    v_perm_b32 v112, v31, v31, v16
    v_perm_b32 v113, v31, v31, v17
    v_perm_b32 v114, v31, v31, v18
    v_perm_b32 v115, v31, v31, v19
    s_waitcnt vmcnt(4)
    v_mfma_f32_16x16x32_bf16 v[120:123], v[116:119], v[92:95], v[120:123]
    v_perm_b32 v116, v31, v31, v20
    v_perm_b32 v117, v31, v31, v21
    v_perm_b32 v118, v31, v31, v22
    v_perm_b32 v119, v31, v31, v23
    s_waitcnt vmcnt(3)
    v_mfma_f32_16x16x32_bf16 v[120:123], v[112:115], v[96:99], v[120:123]
    v_perm_b32 v112, v32, v32, v16
    v_perm_b32 v113, v32, v32, v17
    v_perm_b32 v114, v32, v32, v18
    v_perm_b32 v115, v32, v32, v19
    s_waitcnt vmcnt(2)
    v_mfma_f32_16x16x32_bf16 v[120:123], v[116:119], v[100:103], v[120:123]
    v_perm_b32 v116, v32, v32, v20
    v_perm_b32 v117, v32, v32, v21
    v_perm_b32 v118, v32, v32, v22
    v_perm_b32 v119, v32, v32, v23
    s_waitcnt vmcnt(1)
    v_mfma_f32_16x16x32_bf16 v[120:123], v[112:115], v[104:107], v[120:123]
    s_nop 1
    s_waitcnt vmcnt(0)
    v_mfma_f32_16x16x32_bf16 v[120:123], v[116:119], v[108:111], v[120:123]
    s_waitcnt lgkmcnt(0)
    s_mul_i32 s47, s47, 0x9E3779B1
    s_add_u32 s47, s47, 0x7F4A7C15
    s_mov_b32 s24, 0x7060500
    s_mov_b32 s25, 0x7060501
    s_mov_b32 s26, 0x7060502
    s_mov_b32 s27, 0x7060503
    s_mov_b32 s28, 0x0c0c0400
    s_mov_b32 s29, 0x0c040100
    s_mov_b32 s30, 0x04020100
    s_mov_b32 s31, 0xffffff00
    v_mov_b32 v1, s47
    v_perm_b32 v112, v120, v1, s24
    v_perm_b32 v113, v121, v1, s25
    v_perm_b32 v114, v122, v1, s26
    v_perm_b32 v115, v123, v1, s27
    buffer_store_dwordx4 v[112:115], v10, s[60:63], s11 offen
    s_cmp_eq_u32 s5, 0
    s_cbranch_scc1 L_q_placed
    s_mov_b64 s[72:73], exec
    s_mov_b64 exec, -1
    buffer_store_dwordx4 v[112:115], v10, s[60:63], s11 offen sc1
    s_mov_b64 exec, s[72:73]
    s_waitcnt vmcnt(0)
L_q_placed:
    s_waitcnt vmcnt(1)
    v_mov_b32 v144, 0
    v_lshlrev_b32 v145, 16, v124
    v_and_b32 v146, 0xffff0000, v124
    v_lshlrev_b32 v147, 16, v134
    v_and_b32 v148, 0xffff0000, v134
    v_mul_f32 v145, v145, v147
    v_mul_f32 v146, v146, v148
    v_cvt_pk_bf16_f32 v145, v145, v146
    v_lshlrev_b32 v146, 16, v145
    v_and_b32 v145, 0xffff0000, v145
    v_add_f32 v144, v144, v146
    v_add_f32 v144, v144, v145
    v_lshlrev_b32 v145, 16, v125
    v_and_b32 v146, 0xffff0000, v125
    v_lshlrev_b32 v147, 16, v135
    v_and_b32 v148, 0xffff0000, v135
    v_mul_f32 v145, v145, v147
    v_mul_f32 v146, v146, v148
    v_cvt_pk_bf16_f32 v145, v145, v146
    v_lshlrev_b32 v146, 16, v145
    v_and_b32 v145, 0xffff0000, v145
    v_add_f32 v144, v144, v146
    v_add_f32 v144, v144, v145
    v_lshlrev_b32 v145, 16, v126
    v_and_b32 v146, 0xffff0000, v126
    v_lshlrev_b32 v147, 16, v136
    v_and_b32 v148, 0xffff0000, v136
    v_mul_f32 v145, v145, v147
    v_mul_f32 v146, v146, v148
    v_cvt_pk_bf16_f32 v145, v145, v146
    v_lshlrev_b32 v146, 16, v145
    v_and_b32 v145, 0xffff0000, v145
    v_add_f32 v144, v144, v146
    v_add_f32 v144, v144, v145
    v_lshlrev_b32 v145, 16, v127
    v_and_b32 v146, 0xffff0000, v127
    v_lshlrev_b32 v147, 16, v137
    v_and_b32 v148, 0xffff0000, v137
    v_mul_f32 v145, v145, v147
    v_mul_f32 v146, v146, v148
    v_cvt_pk_bf16_f32 v145, v145, v146
    v_lshlrev_b32 v146, 16, v145
    v_and_b32 v145, 0xffff0000, v145
    v_add_f32 v144, v144, v146
    v_add_f32 v144, v144, v145
    v_lshlrev_b32 v145, 16, v128
    v_and_b32 v146, 0xffff0000, v128
    v_lshlrev_b32 v147, 16, v138
    v_and_b32 v148, 0xffff0000, v138
    v_mul_f32 v145, v145, v147
    v_mul_f32 v146, v146, v148
    v_cvt_pk_bf16_f32 v145, v145, v146
    v_lshlrev_b32 v146, 16, v145
    v_and_b32 v145, 0xffff0000, v145
    v_add_f32 v144, v144, v146
    v_add_f32 v144, v144, v145
    v_lshlrev_b32 v145, 16, v129
    v_and_b32 v146, 0xffff0000, v129
    v_lshlrev_b32 v147, 16, v139
    v_and_b32 v148, 0xffff0000, v139
    v_mul_f32 v145, v145, v147
    v_mul_f32 v146, v146, v148
    v_cvt_pk_bf16_f32 v145, v145, v146
    v_lshlrev_b32 v146, 16, v145
    v_and_b32 v145, 0xffff0000, v145
    v_add_f32 v144, v144, v146
    v_add_f32 v144, v144, v145
    v_lshlrev_b32 v145, 16, v130
    v_and_b32 v146, 0xffff0000, v130
    v_lshlrev_b32 v147, 16, v140
    v_and_b32 v148, 0xffff0000, v140
    v_mul_f32 v145, v145, v147
    v_mul_f32 v146, v146, v148
    v_cvt_pk_bf16_f32 v145, v145, v146
    v_lshlrev_b32 v146, 16, v145
    v_and_b32 v145, 0xffff0000, v145
    v_add_f32 v144, v144, v146
    v_add_f32 v144, v144, v145
    v_lshlrev_b32 v145, 16, v131
    v_and_b32 v146, 0xffff0000, v131
    v_lshlrev_b32 v147, 16, v141
    v_and_b32 v148, 0xffff0000, v141
    v_mul_f32 v145, v145, v147
    v_mul_f32 v146, v146, v148
    v_cvt_pk_bf16_f32 v145, v145, v146
    v_lshlrev_b32 v146, 16, v145
    v_and_b32 v145, 0xffff0000, v145
    v_add_f32 v144, v144, v146
    v_add_f32 v144, v144, v145
    v_lshlrev_b32 v145, 16, v132
    v_and_b32 v146, 0xffff0000, v132
    v_lshlrev_b32 v147, 16, v142
    v_and_b32 v148, 0xffff0000, v142
    v_mul_f32 v145, v145, v147
    v_mul_f32 v146, v146, v148
    v_cvt_pk_bf16_f32 v145, v145, v146
    v_lshlrev_b32 v146, 16, v145
    v_and_b32 v145, 0xffff0000, v145
    v_add_f32 v144, v144, v146
    v_add_f32 v144, v144, v145
    s_nop 1
    v_add_f32_dpp v144, v144, v144 quad_perm:[1,0,3,2] row_mask:0xf bank_mask:0xf
    s_nop 1
    v_add_f32_dpp v144, v144, v144 quad_perm:[2,3,0,1] row_mask:0xf bank_mask:0xf
    s_nop 1
    v_add_f32_dpp v144, v144, v144 row_half_mirror row_mask:0xf bank_mask:0xf
    s_nop 1
    v_add_f32_dpp v144, v144, v144 row_mirror row_mask:0xf bank_mask:0xf
    v_mov_b32 v145, v144
    s_nop 1
    v_permlane16_swap_b32 v144, v145
    s_nop 1
    v_add_f32 v144, v144, v145
    v_cvt_pk_bf16_f32 v144, v144, v144
    v_and_b32 v144, 0xffff0000, v144
    v_mul_f32 v144, 0xbfb8aa3b, v144
    v_exp_f32 v144, v144
    s_nop 0
    v_add_f32 v144, 1.0, v144
    v_rcp_f32 v144, v144
    s_nop 0
    v_cvt_pk_bf16_f32 v144, v144, v144
    v_and_b32 v144, 0xffff0000, v144
    v_sub_f32 v145, 1.0, v144
    v_cvt_pk_bf16_f32 v145, v145, v145
    v_and_b32 v145, 0xffff0000, v145
    v_lshlrev_b32 v7, 3, v7
    s_mov_b32 exec_lo, 1
    s_mov_b32 exec_hi, 1
    ds_write_b64 v7, v[144:145] offset:1088
    s_mov_b64 exec, -1
    s_or_b32 s75, s75, 15
    buffer_load_dwordx4 v[40:43], v12, s[60:63], s64 offen offset:0 sc1 nt
    buffer_load_dwordx4 v[44:47], v12, s[60:63], s64 offen offset:1024 sc1 nt
    buffer_load_dwordx4 v[48:51], v12, s[60:63], s64 offen offset:2048 sc1 nt
    buffer_load_dwordx4 v[52:55], v12, s[60:63], s64 offen offset:3072 sc1 nt
    buffer_load_dwordx4 v[56:59], v12, s[60:63], s65 offen offset:0 sc1 nt
    buffer_load_dwordx4 v[60:63], v12, s[60:63], s65 offen offset:1024 sc1 nt
    buffer_load_dwordx4 v[64:67], v12, s[60:63], s65 offen offset:2048 sc1 nt
    buffer_load_dwordx4 v[68:71], v12, s[60:63], s65 offen offset:3072 sc1 nt
L_poll_q:
    s_waitcnt vmcnt(0)
    s_mov_b64 exec, -1
    v_perm_b32 v145, v41, v40, s28
    v_perm_b32 v145, v42, v145, s29
    v_perm_b32 v145, v43, v145, s30
    v_cmpx_eq_u32 vcc, s47, v145
    v_perm_b32 v145, v45, v44, s28
    v_perm_b32 v145, v46, v145, s29
    v_perm_b32 v145, v47, v145, s30
    v_cmpx_eq_u32 vcc, s47, v145
    v_perm_b32 v145, v49, v48, s28
    v_perm_b32 v145, v50, v145, s29
    v_perm_b32 v145, v51, v145, s30
    v_cmpx_eq_u32 vcc, s47, v145
    v_perm_b32 v145, v53, v52, s28
    v_perm_b32 v145, v54, v145, s29
    v_perm_b32 v145, v55, v145, s30
    v_cmpx_eq_u32 vcc, s47, v145
    v_perm_b32 v145, v57, v56, s28
    v_perm_b32 v145, v58, v145, s29
    v_perm_b32 v145, v59, v145, s30
    v_cmpx_eq_u32 vcc, s47, v145
    v_perm_b32 v145, v61, v60, s28
    v_perm_b32 v145, v62, v145, s29
    v_perm_b32 v145, v63, v145, s30
    v_cmpx_eq_u32 vcc, s47, v145
    v_perm_b32 v145, v65, v64, s28
    v_perm_b32 v145, v66, v145, s29
    v_perm_b32 v145, v67, v145, s30
    v_cmpx_eq_u32 vcc, s47, v145
    v_perm_b32 v145, v69, v68, s28
    v_perm_b32 v145, v70, v145, s29
    v_perm_b32 v145, v71, v145, s30
    v_cmpx_eq_u32 vcc, s47, v145
    s_nop 1
    s_andn2_b64 exec, -1, exec
    s_cbranch_scc0 L_ok_q
    s_bcnt1_i32_b64 s74, exec
    s_sleep 4
    buffer_load_dwordx4 v[40:43], v12, s[60:63], s64 offen offset:0 sc1 nt
    buffer_load_dwordx4 v[44:47], v12, s[60:63], s64 offen offset:1024 sc1 nt
    buffer_load_dwordx4 v[48:51], v12, s[60:63], s64 offen offset:2048 sc1 nt
    buffer_load_dwordx4 v[52:55], v12, s[60:63], s64 offen offset:3072 sc1 nt
    buffer_load_dwordx4 v[56:59], v12, s[60:63], s65 offen offset:0 sc1 nt
    buffer_load_dwordx4 v[60:63], v12, s[60:63], s65 offen offset:1024 sc1 nt
    buffer_load_dwordx4 v[64:67], v12, s[60:63], s65 offen offset:2048 sc1 nt
    buffer_load_dwordx4 v[68:71], v12, s[60:63], s65 offen offset:3072 sc1 nt
    s_and_b32 s74, s75, 15
    s_cbranch_scc1 L_nf_q
    s_mov_b64 s[72:73], exec
    s_mov_b64 exec, -1
    buffer_store_dwordx4 v[112:115], v10, s[60:63], s11 offen sc1
    s_mov_b64 exec, s[72:73]
L_nf_q:
    s_sub_u32 s75, s75, 1
    s_cmp_lg_u32 s75, 0
    s_cbranch_scc1 L_poll_q
    s_waitcnt vmcnt(0)
L_ok_q:
    s_mov_b64 exec, -1
    v_and_b32 v40, s31, v40
    v_and_b32 v41, s31, v41
    v_and_b32 v42, s31, v42
    v_and_b32 v43, s31, v43
    v_and_b32 v44, s31, v44
    v_and_b32 v45, s31, v45
    v_and_b32 v46, s31, v46
    v_and_b32 v47, s31, v47
    v_and_b32 v48, s31, v48
    v_and_b32 v49, s31, v49
    v_and_b32 v50, s31, v50
    v_and_b32 v51, s31, v51
    v_and_b32 v52, s31, v52
    v_and_b32 v53, s31, v53
    v_and_b32 v54, s31, v54
    v_and_b32 v55, s31, v55
    v_and_b32 v56, s31, v56
    v_and_b32 v57, s31, v57
    v_and_b32 v58, s31, v58
    v_and_b32 v59, s31, v59
    v_and_b32 v60, s31, v60
    v_and_b32 v61, s31, v61
    v_and_b32 v62, s31, v62
    v_and_b32 v63, s31, v63
    v_and_b32 v64, s31, v64
    v_and_b32 v65, s31, v65
    v_and_b32 v66, s31, v66
    v_and_b32 v67, s31, v67
    v_and_b32 v68, s31, v68
    v_and_b32 v69, s31, v69
    v_and_b32 v70, s31, v70
    v_and_b32 v71, s31, v71
    v_add_f32 v40, v40, v44
    v_add_f32 v41, v41, v45
    v_add_f32 v42, v42, v46
    v_add_f32 v43, v43, v47
    v_add_f32 v40, v40, v48
    v_add_f32 v41, v41, v49
    v_add_f32 v42, v42, v50
    v_add_f32 v43, v43, v51
    v_add_f32 v40, v40, v52
    v_add_f32 v41, v41, v53
    v_add_f32 v42, v42, v54
    v_add_f32 v43, v43, v55
    v_add_f32 v40, v40, v56
    v_add_f32 v41, v41, v57
    v_add_f32 v42, v42, v58
    v_add_f32 v43, v43, v59
    v_add_f32 v40, v40, v60
    v_add_f32 v41, v41, v61
    v_add_f32 v42, v42, v62
    v_add_f32 v43, v43, v63
    v_add_f32 v40, v40, v64
    v_add_f32 v41, v41, v65
    v_add_f32 v42, v42, v66
    v_add_f32 v43, v43, v67
    v_add_f32 v40, v40, v68
    v_add_f32 v41, v41, v69
    v_add_f32 v42, v42, v70
    v_add_f32 v43, v43, v71
    v_cvt_pk_bf16_f32 v40, v40, v41
    v_cvt_pk_bf16_f32 v41, v42, v43
    ds_write_b64 v14, v[40:41] offset:0
    v_mov_b32 v5, 1
    v_mov_b32 v4, 0
    s_waitcnt lgkmcnt(0)
    ds_write_b32 v4, v5 offset:1280
    v_mov_b32 v4, 0
    buffer_load_dword v5, v4, s[68:71], s13 offen sc1
    s_waitcnt vmcnt(0)
    v_readfirstlane_b32 s8, v5
    s_cmp_eq_u32 s8, 0
    s_cbranch_scc1 L_nh_q
    s_mov_b64 s[72:73], exec
    s_mov_b64 exec, -1
    buffer_store_dwordx4 v[112:115], v10, s[60:63], s11 offen sc1
    s_mov_b64 exec, s[72:73]
L_nh_q:
    s_waitcnt lgkmcnt(0)
    s_endpgm
L_s1b:
    s_mov_b64 s[56:57], s[30:31]
    s_mov_b32 s58, 9216
    s_mov_b32 s59, 0x20000
    s_mov_b64 s[60:61], s[42:43]
    s_mov_b32 s62, 4194304
    s_mov_b32 s63, 0x20000
    s_mov_b64 s[68:69], s[40:41]
    s_mov_b32 s70, 256
    s_mov_b32 s71, 0x20000
    s_load_dword s47, s[42:43], 0
    v_and_b32 v6, 31, v0
    v_lshrrev_b32 v7, 5, v0
    v_lshlrev_b32 v10, 4, v0
    s_mul_i32 s13, s46, 18
    v_add_u32 v8, s13, v6
    v_lshlrev_b32 v8, 4, v8
    v_cmp_lt_u32 vcc, 8, v6
    v_add_u32 v12, 0xf7, v6
    v_lshlrev_b32 v13, 10, v0
    v_cndmask_b32 v12, v6, v12, vcc
    v_lshlrev_b32 v12, 4, v12
    v_lshl_add_u32 v12, v7, 9, v12
    s_movk_i32 s12, 288
    v_mul_u32_u24 v14, s12, v7
    v_lshl_add_u32 v14, v6, 4, v14
    s_lshl_b32 s64, s7, 14
    s_add_u32 s64, s64, 524288
    s_and_b32 s12, s6, 15
    s_lshl_b32 s12, s12, 10
    s_add_u32 s65, s64, s12
    s_lshl_b32 s12, s44, 13
    s_add_u32 s64, s64, s12
    s_lshl_b32 s13, s7, 2
    s_add_u32 s13, s13, 128
    v_and_b32 v156, 1, v0
    v_lshlrev_b32 v156, 4, v156
    v_bfe_u32 v157, v0, 1, 2
    v_mov_b32 v158, 0x0d0c
    v_mov_b32 v159, 0x0f0e
    v_mov_b32 v160, 0x0c0c0c0c
    v_lshlrev_b32 v158, v156, v158
    v_lshlrev_b32 v159, v156, v159
    v_xor_b32 v158, v158, v160
    v_xor_b32 v159, v159, v160
    v_cmp_eq_u32 vcc, 0, v157
    s_nop 1
    v_cndmask_b32 v16, v160, v158, vcc
    v_cndmask_b32 v20, v160, v159, vcc
    v_cmp_eq_u32 vcc, 1, v157
    s_nop 1
    v_cndmask_b32 v17, v160, v158, vcc
    v_cndmask_b32 v21, v160, v159, vcc
    v_cmp_eq_u32 vcc, 2, v157
    s_nop 1
    v_cndmask_b32 v18, v160, v158, vcc
    v_cndmask_b32 v22, v160, v159, vcc
    v_cmp_eq_u32 vcc, 3, v157
    s_nop 1
    v_cndmask_b32 v19, v160, v158, vcc
    v_cndmask_b32 v23, v160, v159, vcc
    s_barrier
    v_add_u32 v4, s10, v4
    ds_read_b64 v[24:25], v4 offset:2048
    ds_read_b64 v[26:27], v4 offset:2056
    ds_read_b64 v[28:29], v4 offset:2064
    ds_read_b64 v[30:31], v4 offset:2072
    ds_read_b64 v[32:33], v4 offset:2080
    ds_read_b64 v[34:35], v4 offset:2088
    ds_read_b64 v[36:37], v4 offset:2096
    ds_read_b64 v[38:39], v4 offset:2104
    ds_read_b64 v[40:41], v4 offset:2112
    s_waitcnt lgkmcnt(0)
    v_perm_b32 v140, v24, v24, v16
    v_perm_b32 v141, v24, v24, v17
    v_perm_b32 v142, v24, v24, v18
    v_perm_b32 v143, v24, v24, v19
    v_perm_b32 v144, v24, v24, v20
    v_perm_b32 v145, v24, v24, v21
    v_perm_b32 v146, v24, v24, v22
    v_perm_b32 v147, v24, v24, v23
    s_waitcnt vmcnt(23)
    v_mfma_f32_16x16x32_bf16 v[148:151], v[140:143], v[44:47], 0
    s_mov_b64 exec, s[14:15]
    buffer_load_dwordx4 v[44:47], v5, s[52:55], s11 offen nt
    s_add_u32 s11, s11, 9216
    s_mov_b64 exec, -1
    v_perm_b32 v140, v25, v25, v16
    v_perm_b32 v141, v25, v25, v17
    v_perm_b32 v142, v25, v25, v18
    v_perm_b32 v143, v25, v25, v19
    s_waitcnt vmcnt(23)
    v_mfma_f32_16x16x32_bf16 v[148:151], v[144:147], v[48:51], v[148:151]
    s_mov_b64 exec, s[14:15]
    buffer_load_dwordx4 v[48:51], v5, s[52:55], s11 offen nt
    s_add_u32 s11, s11, 9216
    s_mov_b64 exec, -1
    v_perm_b32 v144, v25, v25, v20
    v_perm_b32 v145, v25, v25, v21
    v_perm_b32 v146, v25, v25, v22
    v_perm_b32 v147, v25, v25, v23
    s_waitcnt vmcnt(23)
    v_mfma_f32_16x16x32_bf16 v[148:151], v[140:143], v[52:55], v[148:151]
    s_mov_b64 exec, s[14:15]
    buffer_load_dwordx4 v[52:55], v5, s[52:55], s11 offen nt
    s_add_u32 s11, s11, 9216
    s_mov_b64 exec, -1
    v_perm_b32 v140, v26, v26, v16
    v_perm_b32 v141, v26, v26, v17
    v_perm_b32 v142, v26, v26, v18
    v_perm_b32 v143, v26, v26, v19
    s_waitcnt vmcnt(23)
    v_mfma_f32_16x16x32_bf16 v[148:151], v[144:147], v[56:59], v[148:151]
    s_mov_b64 exec, s[14:15]
    buffer_load_dwordx4 v[56:59], v5, s[52:55], s11 offen nt
    s_add_u32 s11, s11, 9216
    s_mov_b64 exec, -1
    v_perm_b32 v144, v26, v26, v20
    v_perm_b32 v145, v26, v26, v21
    v_perm_b32 v146, v26, v26, v22
    v_perm_b32 v147, v26, v26, v23
    s_waitcnt vmcnt(23)
    v_mfma_f32_16x16x32_bf16 v[148:151], v[140:143], v[60:63], v[148:151]
    s_mov_b64 exec, s[14:15]
    buffer_load_dwordx4 v[60:63], v5, s[52:55], s11 offen nt
    s_add_u32 s11, s11, 9216
    s_mov_b64 exec, -1
    v_perm_b32 v140, v27, v27, v16
    v_perm_b32 v141, v27, v27, v17
    v_perm_b32 v142, v27, v27, v18
    v_perm_b32 v143, v27, v27, v19
    s_waitcnt vmcnt(23)
    v_mfma_f32_16x16x32_bf16 v[148:151], v[144:147], v[64:67], v[148:151]
    s_mov_b64 exec, s[14:15]
    buffer_load_dwordx4 v[64:67], v5, s[52:55], s11 offen nt
    s_add_u32 s11, s11, 9216
    s_mov_b64 exec, -1
    v_perm_b32 v144, v27, v27, v20
    v_perm_b32 v145, v27, v27, v21
    v_perm_b32 v146, v27, v27, v22
    v_perm_b32 v147, v27, v27, v23
    s_waitcnt vmcnt(23)
    v_mfma_f32_16x16x32_bf16 v[148:151], v[140:143], v[68:71], v[148:151]
    s_mov_b64 exec, s[14:15]
    buffer_load_dwordx4 v[68:71], v5, s[52:55], s11 offen nt
    s_add_u32 s11, s11, 9216
    s_mov_b64 exec, -1
    v_perm_b32 v140, v28, v28, v16
    v_perm_b32 v141, v28, v28, v17
    v_perm_b32 v142, v28, v28, v18
    v_perm_b32 v143, v28, v28, v19
    s_waitcnt vmcnt(23)
    v_mfma_f32_16x16x32_bf16 v[148:151], v[144:147], v[72:75], v[148:151]
    s_mov_b64 exec, s[14:15]
    buffer_load_dwordx4 v[72:75], v5, s[52:55], s11 offen nt
    s_add_u32 s11, s11, 9216
    s_mov_b64 exec, -1
    v_perm_b32 v144, v28, v28, v20
    v_perm_b32 v145, v28, v28, v21
    v_perm_b32 v146, v28, v28, v22
    v_perm_b32 v147, v28, v28, v23
    s_waitcnt vmcnt(23)
    v_mfma_f32_16x16x32_bf16 v[148:151], v[140:143], v[76:79], v[148:151]
    s_mov_b64 exec, s[14:15]
    buffer_load_dwordx4 v[76:79], v5, s[52:55], s11 offen nt
    s_add_u32 s11, s11, 9216
    s_mov_b64 exec, -1
    v_perm_b32 v140, v29, v29, v16
    v_perm_b32 v141, v29, v29, v17
    v_perm_b32 v142, v29, v29, v18
    v_perm_b32 v143, v29, v29, v19
    s_waitcnt vmcnt(23)
    v_mfma_f32_16x16x32_bf16 v[148:151], v[144:147], v[80:83], v[148:151]
    s_mov_b64 exec, s[14:15]
    buffer_load_dwordx4 v[80:83], v5, s[52:55], s11 offen nt
    s_add_u32 s11, s11, 9216
    s_mov_b64 exec, -1
    v_perm_b32 v144, v29, v29, v20
    v_perm_b32 v145, v29, v29, v21
    v_perm_b32 v146, v29, v29, v22
    v_perm_b32 v147, v29, v29, v23
    s_waitcnt vmcnt(23)
    v_mfma_f32_16x16x32_bf16 v[148:151], v[140:143], v[84:87], v[148:151]
    s_mov_b64 exec, s[14:15]
    buffer_load_dwordx4 v[84:87], v5, s[52:55], s11 offen nt
    s_add_u32 s11, s11, 9216
    s_mov_b64 exec, -1
    v_perm_b32 v140, v30, v30, v16
    v_perm_b32 v141, v30, v30, v17
    v_perm_b32 v142, v30, v30, v18
    v_perm_b32 v143, v30, v30, v19
    s_waitcnt vmcnt(23)
    v_mfma_f32_16x16x32_bf16 v[148:151], v[144:147], v[88:91], v[148:151]
    s_mov_b64 exec, s[14:15]
    buffer_load_dwordx4 v[88:91], v5, s[52:55], s11 offen nt
    s_add_u32 s11, s11, 9216
    s_mov_b64 exec, -1
    v_perm_b32 v144, v30, v30, v20
    v_perm_b32 v145, v30, v30, v21
    v_perm_b32 v146, v30, v30, v22
    v_perm_b32 v147, v30, v30, v23
    s_waitcnt vmcnt(23)
    v_mfma_f32_16x16x32_bf16 v[148:151], v[140:143], v[92:95], v[148:151]
    v_perm_b32 v140, v31, v31, v16
    v_perm_b32 v141, v31, v31, v17
    v_perm_b32 v142, v31, v31, v18
    v_perm_b32 v143, v31, v31, v19
    s_waitcnt vmcnt(22)
    v_mfma_f32_16x16x32_bf16 v[148:151], v[144:147], v[96:99], v[148:151]
    v_perm_b32 v144, v31, v31, v20
    v_perm_b32 v145, v31, v31, v21
    v_perm_b32 v146, v31, v31, v22
    v_perm_b32 v147, v31, v31, v23
    s_waitcnt vmcnt(21)
    v_mfma_f32_16x16x32_bf16 v[148:151], v[140:143], v[100:103], v[148:151]
    v_perm_b32 v140, v32, v32, v16
    v_perm_b32 v141, v32, v32, v17
    v_perm_b32 v142, v32, v32, v18
    v_perm_b32 v143, v32, v32, v19
    s_waitcnt vmcnt(20)
    v_mfma_f32_16x16x32_bf16 v[148:151], v[144:147], v[104:107], v[148:151]
    v_perm_b32 v144, v32, v32, v20
    v_perm_b32 v145, v32, v32, v21
    v_perm_b32 v146, v32, v32, v22
    v_perm_b32 v147, v32, v32, v23
    s_waitcnt vmcnt(19)
    v_mfma_f32_16x16x32_bf16 v[148:151], v[140:143], v[108:111], v[148:151]
    v_perm_b32 v140, v33, v33, v16
    v_perm_b32 v141, v33, v33, v17
    v_perm_b32 v142, v33, v33, v18
    v_perm_b32 v143, v33, v33, v19
    s_waitcnt vmcnt(18)
    v_mfma_f32_16x16x32_bf16 v[148:151], v[144:147], v[112:115], v[148:151]
    v_perm_b32 v144, v33, v33, v20
    v_perm_b32 v145, v33, v33, v21
    v_perm_b32 v146, v33, v33, v22
    v_perm_b32 v147, v33, v33, v23
    s_waitcnt vmcnt(17)
    v_mfma_f32_16x16x32_bf16 v[148:151], v[140:143], v[116:119], v[148:151]
    v_perm_b32 v140, v34, v34, v16
    v_perm_b32 v141, v34, v34, v17
    v_perm_b32 v142, v34, v34, v18
    v_perm_b32 v143, v34, v34, v19
    s_waitcnt vmcnt(16)
    v_mfma_f32_16x16x32_bf16 v[148:151], v[144:147], v[120:123], v[148:151]
    v_perm_b32 v144, v34, v34, v20
    v_perm_b32 v145, v34, v34, v21
    v_perm_b32 v146, v34, v34, v22
    v_perm_b32 v147, v34, v34, v23
    s_waitcnt vmcnt(15)
    v_mfma_f32_16x16x32_bf16 v[148:151], v[140:143], v[124:127], v[148:151]
    v_perm_b32 v140, v35, v35, v16
    v_perm_b32 v141, v35, v35, v17
    v_perm_b32 v142, v35, v35, v18
    v_perm_b32 v143, v35, v35, v19
    s_waitcnt vmcnt(14)
    v_mfma_f32_16x16x32_bf16 v[148:151], v[144:147], v[128:131], v[148:151]
    v_perm_b32 v144, v35, v35, v20
    v_perm_b32 v145, v35, v35, v21
    v_perm_b32 v146, v35, v35, v22
    v_perm_b32 v147, v35, v35, v23
    s_waitcnt vmcnt(13)
    v_mfma_f32_16x16x32_bf16 v[148:151], v[140:143], v[132:135], v[148:151]
    v_perm_b32 v140, v36, v36, v16
    v_perm_b32 v141, v36, v36, v17
    v_perm_b32 v142, v36, v36, v18
    v_perm_b32 v143, v36, v36, v19
    s_waitcnt vmcnt(12)
    v_mfma_f32_16x16x32_bf16 v[148:151], v[144:147], v[136:139], v[148:151]
    v_perm_b32 v144, v36, v36, v20
    v_perm_b32 v145, v36, v36, v21
    v_perm_b32 v146, v36, v36, v22
    v_perm_b32 v147, v36, v36, v23
    s_waitcnt vmcnt(11)
    v_mfma_f32_16x16x32_bf16 v[148:151], v[140:143], v[44:47], v[148:151]
    v_perm_b32 v140, v37, v37, v16
    v_perm_b32 v141, v37, v37, v17
    v_perm_b32 v142, v37, v37, v18
    v_perm_b32 v143, v37, v37, v19
    s_waitcnt vmcnt(10)
    v_mfma_f32_16x16x32_bf16 v[148:151], v[144:147], v[48:51], v[148:151]
    v_perm_b32 v144, v37, v37, v20
    v_perm_b32 v145, v37, v37, v21
    v_perm_b32 v146, v37, v37, v22
    v_perm_b32 v147, v37, v37, v23
    s_waitcnt vmcnt(9)
    v_mfma_f32_16x16x32_bf16 v[148:151], v[140:143], v[52:55], v[148:151]
    v_perm_b32 v140, v38, v38, v16
    v_perm_b32 v141, v38, v38, v17
    v_perm_b32 v142, v38, v38, v18
    v_perm_b32 v143, v38, v38, v19
    s_waitcnt vmcnt(8)
    v_mfma_f32_16x16x32_bf16 v[148:151], v[144:147], v[56:59], v[148:151]
    v_perm_b32 v144, v38, v38, v20
    v_perm_b32 v145, v38, v38, v21
    v_perm_b32 v146, v38, v38, v22
    v_perm_b32 v147, v38, v38, v23
    s_waitcnt vmcnt(7)
    v_mfma_f32_16x16x32_bf16 v[148:151], v[140:143], v[60:63], v[148:151]
    v_perm_b32 v140, v39, v39, v16
    v_perm_b32 v141, v39, v39, v17
    v_perm_b32 v142, v39, v39, v18
    v_perm_b32 v143, v39, v39, v19
    s_waitcnt vmcnt(6)
    v_mfma_f32_16x16x32_bf16 v[148:151], v[144:147], v[64:67], v[148:151]
    v_perm_b32 v144, v39, v39, v20
    v_perm_b32 v145, v39, v39, v21
    v_perm_b32 v146, v39, v39, v22
    v_perm_b32 v147, v39, v39, v23
    s_waitcnt vmcnt(5)
    v_mfma_f32_16x16x32_bf16 v[148:151], v[140:143], v[68:71], v[148:151]
    v_perm_b32 v140, v40, v40, v16
    v_perm_b32 v141, v40, v40, v17
    v_perm_b32 v142, v40, v40, v18
    v_perm_b32 v143, v40, v40, v19
    s_waitcnt vmcnt(4)
    v_mfma_f32_16x16x32_bf16 v[148:151], v[144:147], v[72:75], v[148:151]
    v_perm_b32 v144, v40, v40, v20
    v_perm_b32 v145, v40, v40, v21
    v_perm_b32 v146, v40, v40, v22
    v_perm_b32 v147, v40, v40, v23
    s_waitcnt vmcnt(3)
    v_mfma_f32_16x16x32_bf16 v[148:151], v[140:143], v[76:79], v[148:151]
    v_perm_b32 v140, v41, v41, v16
    v_perm_b32 v141, v41, v41, v17
    v_perm_b32 v142, v41, v41, v18
    v_perm_b32 v143, v41, v41, v19
    s_waitcnt vmcnt(2)
    v_mfma_f32_16x16x32_bf16 v[148:151], v[144:147], v[80:83], v[148:151]
    v_perm_b32 v144, v41, v41, v20
    v_perm_b32 v145, v41, v41, v21
    v_perm_b32 v146, v41, v41, v22
    v_perm_b32 v147, v41, v41, v23
    s_waitcnt vmcnt(1)
    v_mfma_f32_16x16x32_bf16 v[148:151], v[140:143], v[84:87], v[148:151]
    s_nop 1
    s_waitcnt vmcnt(0)
    v_mfma_f32_16x16x32_bf16 v[148:151], v[144:147], v[88:91], v[148:151]
    s_waitcnt lgkmcnt(0)
    s_mul_i32 s47, s47, 0x9E3779B1
    s_add_u32 s47, s47, 0x7F4A7C15
    s_mov_b32 s24, 0x7060500
    s_mov_b32 s25, 0x7060501
    s_mov_b32 s26, 0x7060502
    s_mov_b32 s27, 0x7060503
    s_mov_b32 s28, 0x0c0c0400
    s_mov_b32 s29, 0x0c040100
    s_mov_b32 s30, 0x04020100
    s_mov_b32 s31, 0xffffff00
    v_mov_b32 v1, s47
    v_perm_b32 v140, v148, v1, s24
    v_perm_b32 v141, v149, v1, s25
    v_perm_b32 v142, v150, v1, s26
    v_perm_b32 v143, v151, v1, s27
    buffer_store_dwordx4 v[140:143], v10, s[60:63], s65 offen
    s_cmp_eq_u32 s5, 0
    s_cbranch_scc1 L_h_placed
    s_mov_b64 s[72:73], exec
    s_mov_b64 exec, -1
    buffer_store_dwordx4 v[140:143], v10, s[60:63], s65 offen sc1
    s_mov_b64 exec, s[72:73]
L_h_placed:
    s_mov_b32 s14, 0x0003ffff
    s_mov_b32 s15, 0x0003ffff
    s_mov_b64 exec, s[14:15]
    buffer_load_dwordx4 v[152:155], v8, s[56:59], 0 offen
    s_or_b32 s75, s75, 15
    buffer_load_dwordx4 v[44:47], v12, s[60:63], s64 offen offset:0 sc1 nt
    buffer_load_dwordx4 v[48:51], v12, s[60:63], s64 offen offset:256 sc1 nt
    buffer_load_dwordx4 v[52:55], v12, s[60:63], s64 offen offset:1024 sc1 nt
    buffer_load_dwordx4 v[56:59], v12, s[60:63], s64 offen offset:1280 sc1 nt
    buffer_load_dwordx4 v[60:63], v12, s[60:63], s64 offen offset:2048 sc1 nt
    buffer_load_dwordx4 v[64:67], v12, s[60:63], s64 offen offset:2304 sc1 nt
    buffer_load_dwordx4 v[68:71], v12, s[60:63], s64 offen offset:3072 sc1 nt
    buffer_load_dwordx4 v[72:75], v12, s[60:63], s64 offen offset:3328 sc1 nt
L_poll_h:
    s_waitcnt vmcnt(0)
    s_mov_b64 exec, s[14:15]
    v_perm_b32 v156, v45, v44, s28
    v_perm_b32 v156, v46, v156, s29
    v_perm_b32 v156, v47, v156, s30
    v_cmpx_eq_u32 vcc, s47, v156
    v_perm_b32 v156, v49, v48, s28
    v_perm_b32 v156, v50, v156, s29
    v_perm_b32 v156, v51, v156, s30
    v_cmpx_eq_u32 vcc, s47, v156
    v_perm_b32 v156, v53, v52, s28
    v_perm_b32 v156, v54, v156, s29
    v_perm_b32 v156, v55, v156, s30
    v_cmpx_eq_u32 vcc, s47, v156
    v_perm_b32 v156, v57, v56, s28
    v_perm_b32 v156, v58, v156, s29
    v_perm_b32 v156, v59, v156, s30
    v_cmpx_eq_u32 vcc, s47, v156
    v_perm_b32 v156, v61, v60, s28
    v_perm_b32 v156, v62, v156, s29
    v_perm_b32 v156, v63, v156, s30
    v_cmpx_eq_u32 vcc, s47, v156
    v_perm_b32 v156, v65, v64, s28
    v_perm_b32 v156, v66, v156, s29
    v_perm_b32 v156, v67, v156, s30
    v_cmpx_eq_u32 vcc, s47, v156
    v_perm_b32 v156, v69, v68, s28
    v_perm_b32 v156, v70, v156, s29
    v_perm_b32 v156, v71, v156, s30
    v_cmpx_eq_u32 vcc, s47, v156
    v_perm_b32 v156, v73, v72, s28
    v_perm_b32 v156, v74, v156, s29
    v_perm_b32 v156, v75, v156, s30
    v_cmpx_eq_u32 vcc, s47, v156
    s_nop 1
    s_andn2_b64 exec, s[14:15], exec
    s_cbranch_scc0 L_ok_h
    s_bcnt1_i32_b64 s74, exec
    s_sleep 4
    buffer_load_dwordx4 v[44:47], v12, s[60:63], s64 offen offset:0 sc1 nt
    buffer_load_dwordx4 v[48:51], v12, s[60:63], s64 offen offset:256 sc1 nt
    buffer_load_dwordx4 v[52:55], v12, s[60:63], s64 offen offset:1024 sc1 nt
    buffer_load_dwordx4 v[56:59], v12, s[60:63], s64 offen offset:1280 sc1 nt
    buffer_load_dwordx4 v[60:63], v12, s[60:63], s64 offen offset:2048 sc1 nt
    buffer_load_dwordx4 v[64:67], v12, s[60:63], s64 offen offset:2304 sc1 nt
    buffer_load_dwordx4 v[68:71], v12, s[60:63], s64 offen offset:3072 sc1 nt
    buffer_load_dwordx4 v[72:75], v12, s[60:63], s64 offen offset:3328 sc1 nt
    s_and_b32 s74, s75, 15
    s_cbranch_scc1 L_nf_h
    s_mov_b64 s[72:73], exec
    s_mov_b64 exec, -1
    buffer_store_dwordx4 v[140:143], v10, s[60:63], s65 offen sc1
    s_mov_b64 exec, s[72:73]
L_nf_h:
    s_sub_u32 s75, s75, 1
    s_cmp_lg_u32 s75, 0
    s_cbranch_scc1 L_poll_h
    s_waitcnt vmcnt(0)
L_ok_h:
    s_mov_b64 exec, s[14:15]
    v_and_b32 v44, s31, v44
    v_and_b32 v45, s31, v45
    v_and_b32 v46, s31, v46
    v_and_b32 v47, s31, v47
    v_and_b32 v48, s31, v48
    v_and_b32 v49, s31, v49
    v_and_b32 v50, s31, v50
    v_and_b32 v51, s31, v51
    v_and_b32 v52, s31, v52
    v_and_b32 v53, s31, v53
    v_and_b32 v54, s31, v54
    v_and_b32 v55, s31, v55
    v_and_b32 v56, s31, v56
    v_and_b32 v57, s31, v57
    v_and_b32 v58, s31, v58
    v_and_b32 v59, s31, v59
    v_and_b32 v60, s31, v60
    v_and_b32 v61, s31, v61
    v_and_b32 v62, s31, v62
    v_and_b32 v63, s31, v63
    v_and_b32 v64, s31, v64
    v_and_b32 v65, s31, v65
    v_and_b32 v66, s31, v66
    v_and_b32 v67, s31, v67
    v_and_b32 v68, s31, v68
    v_and_b32 v69, s31, v69
    v_and_b32 v70, s31, v70
    v_and_b32 v71, s31, v71
    v_and_b32 v72, s31, v72
    v_and_b32 v73, s31, v73
    v_and_b32 v74, s31, v74
    v_and_b32 v75, s31, v75
    v_add_f32 v44, v44, v52
    v_add_f32 v45, v45, v53
    v_add_f32 v46, v46, v54
    v_add_f32 v47, v47, v55
    v_add_f32 v48, v48, v56
    v_add_f32 v49, v49, v57
    v_add_f32 v50, v50, v58
    v_add_f32 v51, v51, v59
    v_add_f32 v44, v44, v60
    v_add_f32 v45, v45, v61
    v_add_f32 v46, v46, v62
    v_add_f32 v47, v47, v63
    v_add_f32 v48, v48, v64
    v_add_f32 v49, v49, v65
    v_add_f32 v50, v50, v66
    v_add_f32 v51, v51, v67
    v_add_f32 v44, v44, v68
    v_add_f32 v45, v45, v69
    v_add_f32 v46, v46, v70
    v_add_f32 v47, v47, v71
    v_add_f32 v48, v48, v72
    v_add_f32 v49, v49, v73
    v_add_f32 v50, v50, v74
    v_add_f32 v51, v51, v75
    v_cvt_pk_bf16_f32 v44, v44, v45
    v_lshlrev_b32 v160, 16, v152
    v_and_b32 v161, 0xffff0000, v152
    v_and_b32 v45, 0xffff0000, v44
    v_lshlrev_b32 v44, 16, v44
    v_add_f32 v44, v44, v160
    v_add_f32 v45, v45, v161
    v_cvt_pk_bf16_f32 v44, v44, v45
    v_and_b32 v45, 0xffff0000, v44
    v_lshlrev_b32 v44, 16, v44
    v_max_f32 v44, 0, v44
    v_max_f32 v45, 0, v45
    v_mul_f32 v44, v44, v44
    v_mul_f32 v45, v45, v45
    v_cvt_pk_bf16_f32 v156, v44, v45
    v_cvt_pk_bf16_f32 v46, v46, v47
    v_lshlrev_b32 v160, 16, v153
    v_and_b32 v161, 0xffff0000, v153
    v_and_b32 v47, 0xffff0000, v46
    v_lshlrev_b32 v46, 16, v46
    v_add_f32 v46, v46, v160
    v_add_f32 v47, v47, v161
    v_cvt_pk_bf16_f32 v46, v46, v47
    v_and_b32 v47, 0xffff0000, v46
    v_lshlrev_b32 v46, 16, v46
    v_max_f32 v46, 0, v46
    v_max_f32 v47, 0, v47
    v_mul_f32 v46, v46, v46
    v_mul_f32 v47, v47, v47
    v_cvt_pk_bf16_f32 v157, v46, v47
    v_cvt_pk_bf16_f32 v48, v48, v49
    v_lshlrev_b32 v160, 16, v154
    v_and_b32 v161, 0xffff0000, v154
    v_and_b32 v49, 0xffff0000, v48
    v_lshlrev_b32 v48, 16, v48
    v_add_f32 v48, v48, v160
    v_add_f32 v49, v49, v161
    v_cvt_pk_bf16_f32 v48, v48, v49
    v_and_b32 v49, 0xffff0000, v48
    v_lshlrev_b32 v48, 16, v48
    v_max_f32 v48, 0, v48
    v_max_f32 v49, 0, v49
    v_mul_f32 v48, v48, v48
    v_mul_f32 v49, v49, v49
    v_cvt_pk_bf16_f32 v158, v48, v49
    v_cvt_pk_bf16_f32 v50, v50, v51
    v_lshlrev_b32 v160, 16, v155
    v_and_b32 v161, 0xffff0000, v155
    v_and_b32 v51, 0xffff0000, v50
    v_lshlrev_b32 v50, 16, v50
    v_add_f32 v50, v50, v160
    v_add_f32 v51, v51, v161
    v_cvt_pk_bf16_f32 v50, v50, v51
    v_and_b32 v51, 0xffff0000, v50
    v_lshlrev_b32 v50, 16, v50
    v_max_f32 v50, 0, v50
    v_max_f32 v51, 0, v51
    v_mul_f32 v50, v50, v50
    v_mul_f32 v51, v51, v51
    v_cvt_pk_bf16_f32 v159, v50, v51
    ds_write_b128 v14, v[156:159] offset:512
    s_mov_b64 exec, -1
    v_mov_b32 v4, 0
    buffer_load_dword v5, v4, s[68:71], s13 offen sc1
    s_waitcnt vmcnt(0)
    v_readfirstlane_b32 s8, v5
    s_cmp_eq_u32 s8, 0
    s_cbranch_scc1 L_nh_h
    s_mov_b64 s[72:73], exec
    s_mov_b64 exec, -1
    buffer_store_dwordx4 v[140:143], v10, s[60:63], s65 offen sc1
    s_mov_b64 exec, s[72:73]
L_nh_h:
    s_waitcnt lgkmcnt(0)
L_end:
    s_endpgm
.section .rodata,"a"
.p2align 6
.amdhsa_kernel gated_mix__sliding_block_cached__dense_activation_squared_relu__decode_kernel
  .amdhsa_next_free_vgpr 168
  .amdhsa_next_free_sgpr 102
  .amdhsa_accum_offset 168
  .amdhsa_group_segment_fixed_size 0
  .amdhsa_kernarg_size 112
  .amdhsa_user_sgpr_count 2
  .amdhsa_user_sgpr_kernarg_segment_ptr 1
  .amdhsa_system_sgpr_workgroup_id_x 1
  .amdhsa_float_denorm_mode_32 3
.end_amdhsa_kernel
```
